```python
import torch

def _softmax(x, axis=-1):
    return torch.softmax(x, dim=axis)
def _gelu(x):
    return torch.nn.functional.gelu(x, approximate="tanh")
def _silu(x):
    return torch.nn.functional.silu(x)
def _sigmoid(x):
    return torch.sigmoid(x)
def _layernorm(x, axis=-1, eps=1e-5):
    m = x.mean(dim=axis, keepdim=True)
    v = x.var(dim=axis, keepdim=True, unbiased=False)
    return (x - m) / torch.sqrt(v + eps)
def _scatter_add(tgt, idx, src, axis=0):
    return tgt.clone().index_add_(axis, idx, src)
def _segment_sum(src, seg, n):
    out = torch.zeros((n,) + src.shape[1:], dtype=src.dtype)
    return out.index_add_(0, seg, src)
def _pad(x, pw):
    flat = tuple(v for pair in reversed(pw) for v in pair)
    return torch.nn.functional.pad(x, flat)

kernel_name = 'standalone__normalfloat_lut_codebook_lookup__prompt'

def setup_inputs():

    _w = (lambda a: (lambda t: t.to(torch.bfloat16) if t.is_floating_point() else t)(torch.as_tensor(a)))
    B, S, D, F = 1, 2048, 1024, 3584
    G = 64 if 64 > 0 else D
    D = (D // G) * G
    ng = D // G
    nf4 = torch.tensor([
        -1.0, -0.6961928009986877, -0.5250730514526367, -0.39491748809814453,
        -0.28444138169288635, -0.18477343022823334, -0.09105003625154495, 0.0,
        0.07958029955625534, 0.16093020141124725, 0.24611230194568634, 0.33791524171829224,
        0.44070982933044434, 0.5626170039176941, 0.7229568362236023, 1.0
    ], dtype=float)
    qw = torch.randint(0, 16, (D, F)).to(torch.int64)
    absmax = (torch.abs((lambda *s: torch.randn(*s, dtype=torch.bfloat16) * 0.05)(ng, F)) + 0.01).to(float)
    return {
        "x": _w((lambda *s: torch.randn(*s, dtype=torch.bfloat16) * 0.05)(B, S, D)),
        "qw": _w(qw),
        "codebook": _w(nf4),
        "absmax": _w(absmax),
    }

def reference(x, qw, codebook, absmax):
    B, S, D = x.shape
    ng, F = absmax.shape
    G = D // ng
    w_nf = codebook[qw]
    s = (lambda x, n, axis: torch.repeat_interleave(x, n, dim=axis))(absmax, G, axis=0)
    w = (lambda x, dt: x.to(dt))(w_nf * s, x.dtype)
    return torch.einsum("bsd,df->bsf", x, w)
```

```asm
; @launch grid=(256,1,1) block=(512,1,1) lds=148480
.amdgcn_target "amdgcn-amd-amdhsa--gfx950"
.text
.globl standalone__normalfloat_lut_codebook_lookup__prompt_kernel
.p2align 8
.type standalone__normalfloat_lut_codebook_lookup__prompt_kernel,@function
standalone__normalfloat_lut_codebook_lookup__prompt_kernel:
    s_cmp_ge_u32 s2, 256
    s_cbranch_scc1 L_end
    s_load_dwordx2 s[24:25], s[0:1], 8
    s_load_dwordx2 s[28:29], s[0:1], 24
    s_load_dwordx2 s[32:33], s[0:1], 16
    s_load_dwordx2 s[20:21], s[0:1], 0
    s_load_dwordx4 s[12:15], s[0:1], 32
    s_load_dwordx2 s[36:37], s[0:1], 48
    s_memrealtime s[60:61]
    v_lshrrev_b32 v1, 6, v0
    v_and_b32 v0, 63, v0
    v_readfirstlane_b32 s3, v1
L_pc:
    s_getpc_b64 s[18:19]
    s_sub_u32 s18, s18, L_pc+4-standalone__normalfloat_lut_codebook_lookup__prompt_kernel
    s_subb_u32 s19, s19, 0
    s_cmp_lt_u32 s3, 4
    s_cbranch_scc1 L_npf
    v_lshlrev_b32 v2, 7, v0
    s_and_b32 s45, s3, 3
    s_lshl_b32 s45, s45, 13
    v_add_u32 v2, s45, v2
    v_min_u32 v2, L_last-standalone__normalfloat_lut_codebook_lookup__prompt_kernel-4, v2
    global_load_dword v255, v2, s[18:19]
L_npf:
    s_and_b32 s44, s2, 1
    s_lshl_b32 s44, s44, 2
    s_bfe_u32 s40, s2, 0x20003
    s_add_u32 s40, s40, s44
    s_bfe_u32 s41, s2, 0x20001
    s_lshl_b32 s41, s41, 3
    s_lshr_b32 s46, s2, 5
    s_add_u32 s41, s41, s46
    s_and_b32 s42, s41, 1
    s_lshr_b32 s47, s41, 1
    s_and_b32 s43, s3, 3
    s_add_u32 s58, s40, 8
    v_and_b32 v3, 31, v0
    v_lshrrev_b32 v4, 5, v0
    s_lshl_b32 s45, s42, 7
    v_lshl_add_u32 v5, v3, 4, s45
    v_and_b32 v5, 511, v5
    s_mul_i32 s46, s47, 896
    s_mul_i32 s57, s42, 384
    s_add_u32 s46, s46, s57
    v_add_u32 v5, s46, v5
    v_lshrrev_b32 v11, 1, v5
    s_lshl_b32 s45, s43, 1
    v_add_u32 v6, s45, v4
    v_mul_u32_u24 v6, 114688, v6
    v_add_u32 v10, v5, v6
    v_and_b32 v6, 15, v0
    v_lshlrev_b32 v6, 1, v6
    s_mov_b32 s26, 14680064
    s_mov_b32 s27, 0x20000
    s_mov_b32 s30, 114688
    s_mov_b32 s31, 0x20000
    s_mov_b32 s34, 32
    s_mov_b32 s35, 0x20000
    s_mov_b32 s22, 4194304
    s_mov_b32 s23, 0x20000
    s_mov_b32 s38, 8404992
    s_mov_b32 s39, 0x20000
    s_mul_i32 s59, s40, 7168
    s_mul_i32 s56, s40, 917504
    s_cmp_ge_u32 s3, 4
    s_cbranch_scc1 L_prod
    s_waitcnt lgkmcnt(0)
    buffer_load_dwordx4 v[16:19], v10, s[24:27], s56 offen
    s_add_u32 s56, s56, 14336
    buffer_load_dwordx4 v[20:23], v10, s[24:27], s56 offen
    s_add_u32 s56, s56, 14336
    buffer_load_dwordx4 v[24:27], v10, s[24:27], s56 offen
    s_add_u32 s56, s56, 14336
    buffer_load_dwordx4 v[28:31], v10, s[24:27], s56 offen
    s_add_u32 s56, s56, 14336
    buffer_load_dwordx4 v[32:35], v10, s[24:27], s56 offen
    s_add_u32 s56, s56, 14336
    buffer_load_dwordx4 v[36:39], v10, s[24:27], s56 offen
    s_add_u32 s56, s56, 14336
    buffer_load_dwordx4 v[40:43], v10, s[24:27], s56 offen
    s_add_u32 s56, s56, 14336
    buffer_load_dwordx4 v[44:47], v10, s[24:27], s56 offen
    buffer_load_dwordx2 v[48:49], v11, s[28:31], s59 offen
    buffer_load_ushort v13, v6, s[32:35], 0 offen
L_nowr:
    s_branch L_cons2
L_prod:
    s_lshl_b32 s44, s40, 8
    s_lshl_b32 s45, s43, 6
    s_add_u32 s44, s44, s45
    v_lshrrev_b32 v1, 4, v0
    v_lshrrev_b32 v240, 3, v0
    s_lshl_b32 s45, s42, 5
    v_xor_b32 v240, s45, v240
    v_add_u32 v240, s44, v240
    v_lshlrev_b32 v240, 11, v240
    v_and_b32 v241, 7, v0
    v_xor_b32 v241, v241, v1
    v_lshl_add_u32 v16, v241, 4, v240
    v_xor_b32 v17, 64, v16
    v_add_u32 v17, 15360, v17
    v_add_u32 v18, 30720, v16
    v_add_u32 v19, 30720, v17
    s_mul_i32 s45, s42, 131072
    s_sub_u32 s45, 65536, s45
    v_add_u32 v20, s45, v16
    v_add_u32 v21, s45, v17
    v_add_u32 v22, s45, v18
    v_add_u32 v23, s45, v19
    s_lshl_b32 s46, s43, 13
    s_add_u32 s46, s46, 1024
    s_waitcnt lgkmcnt(0)
    s_and_b32 s51, s40, 6
    s_lshl_b32 s45, s43, 8
    s_or_b32 s45, s45, s2
    s_cmp_ge_u32 s45, 8
    s_cbranch_scc1 L_nocas
    s_or_b32 s45, s61, 0x40000000
    v_mov_b32 v28, s60
    v_mov_b32 v29, s45
    v_mov_b32 v30, 0
    v_mov_b32 v31, 0
    s_mov_b64 exec, 1
    global_atomic_cmpswap_x2 v30, v[28:31], s[14:15] sc1
    s_mov_b64 exec, -1
L_nocas:
    s_mov_b32 s70, s40
    s_lshl_b32 s50, s70, 7
    s_add_u32 m0, s46, 0
    s_nop 0
    buffer_load_dwordx4 v16, s[20:23], s50 offen offset:0 lds
    buffer_load_dwordx4 v17, s[20:23], s50 offen offset:1024 lds
    buffer_load_dwordx4 v18, s[20:23], s50 offen offset:2048 lds
    buffer_load_dwordx4 v19, s[20:23], s50 offen offset:3072 lds
    s_add_u32 m0, s46, 4096
    s_nop 0
    buffer_load_dwordx4 v20, s[20:23], s50 offen offset:0 lds
    buffer_load_dwordx4 v21, s[20:23], s50 offen offset:1024 lds
    buffer_load_dwordx4 v22, s[20:23], s50 offen offset:2048 lds
    buffer_load_dwordx4 v23, s[20:23], s50 offen offset:3072 lds
    v_lshrrev_b32 v7, 3, v3
    v_lshlrev_b32 v7, 10, v7
    v_and_b32 v8, 7, v3
    v_lshl_add_u32 v7, v8, 4, v7
    v_lshl_add_u32 v12, v4, 8, v7
    v_lshlrev_b32 v14, 1, v6
    s_lshl_b32 s45, s41, 4
    s_add_u32 s45, s45, s58
    s_lshl_b32 s45, s45, 2
    s_add_u32 s45, s45, s43
    s_lshl_b32 s45, s45, 12
    v_add_u32 v88, s45, v12
    s_lshl_b32 s45, s41, 2
    s_add_u32 s45, s45, s43
    s_lshl_b32 s45, s45, 7
    s_add_u32 s45, s45, 8388608
    s_add_u32 s54, s36, s45
    s_addc_u32 s55, s37, 0
    s_lshl_b32 s45, s58, 3
    v_mov_b32 v91, s45
    v_mov_b32 v90, 0
    s_lshl_b32 s45, s43, 12
    s_add_u32 s57, s45, 99328
    v_add_u32 v12, s57, v12
    s_lshl_b32 s45, s41, 18
    s_lshl_b32 s50, s43, 12
    s_add_u32 s45, s45, s50
    v_lshlrev_b32 v15, 4, v0
    v_add_u32 v26, s57, v15
    v_add_u32 v15, s45, v15
    s_mul_i32 s59, s58, 7168
    s_mul_i32 s56, s58, 917504
    buffer_load_dwordx4 v[32:35], v10, s[24:27], s56 offen
    s_add_u32 s56, s56, 14336
    buffer_load_dwordx4 v[36:39], v10, s[24:27], s56 offen
    s_add_u32 s56, s56, 14336
    buffer_load_dwordx4 v[40:43], v10, s[24:27], s56 offen
    s_add_u32 s56, s56, 14336
    buffer_load_dwordx4 v[44:47], v10, s[24:27], s56 offen
    s_add_u32 s56, s56, 14336
    buffer_load_dwordx4 v[48:51], v10, s[24:27], s56 offen
    s_add_u32 s56, s56, 14336
    buffer_load_dwordx4 v[52:55], v10, s[24:27], s56 offen
    s_add_u32 s56, s56, 14336
    buffer_load_dwordx4 v[56:59], v10, s[24:27], s56 offen
    s_add_u32 s56, s56, 14336
    buffer_load_dwordx4 v[60:63], v10, s[24:27], s56 offen
    buffer_load_dwordx2 v[64:65], v11, s[28:31], s59 offen
    s_mov_b32 s71, s58
    s_call_b64 s[74:75], L_stub1
    s_call_b64 s[74:75], L_stub7
    s_call_b64 s[74:75], L_stub13
    s_waitcnt vmcnt(9)
    s_barrier
    global_load_dwordx2 v[92:93], v90, s[14:15] sc1
    s_lshl_b32 s50, s71, 7
    s_add_u32 m0, s46, 32768
    s_nop 0
    buffer_load_dwordx4 v16, s[20:23], s50 offen offset:0 lds
    buffer_load_dwordx4 v17, s[20:23], s50 offen offset:1024 lds
    buffer_load_dwordx4 v18, s[20:23], s50 offen offset:2048 lds
    buffer_load_dwordx4 v19, s[20:23], s50 offen offset:3072 lds
    s_add_u32 m0, s46, 36864
    s_nop 0
    buffer_load_dwordx4 v20, s[20:23], s50 offen offset:0 lds
    buffer_load_dwordx4 v21, s[20:23], s50 offen offset:1024 lds
    buffer_load_dwordx4 v22, s[20:23], s50 offen offset:2048 lds
    buffer_load_dwordx4 v23, s[20:23], s50 offen offset:3072 lds
    s_cmp_le_u32 s40, 0
    s_cselect_b32 s70, 1, 0
    s_waitcnt vmcnt(9)
    v_lshlrev_b32 v32, 2, v32
    v_lshlrev_b32 v33, 2, v33
    v_lshlrev_b32 v34, 2, v34
    v_lshlrev_b32 v35, 2, v35
    v_lshlrev_b32 v36, 2, v36
    s_lshl_b32 s50, s70, 7
    v_lshlrev_b32 v37, 2, v37
    v_lshlrev_b32 v38, 2, v38
    v_lshlrev_b32 v39, 2, v39
    ds_read_b32 v32, v32
    ds_read_b32 v33, v33
    ds_read_b32 v34, v34
    ds_read_b32 v35, v35
    ds_read_b32 v36, v36
    s_add_u32 m0, s46, 65536
    s_nop 0
    ds_read_b32 v37, v37
    ds_read_b32 v38, v38
    ds_read_b32 v39, v39
    v_lshlrev_b32 v68, 16, v64
    v_and_b32 v69, 0xffff0000, v64
    v_lshlrev_b32 v70, 16, v65
    v_and_b32 v71, 0xffff0000, v65
    v_lshlrev_b32 v40, 2, v40
    buffer_load_dwordx4 v16, s[20:23], s50 offen offset:0 lds
    v_lshlrev_b32 v41, 2, v41
    v_lshlrev_b32 v42, 2, v42
    v_lshlrev_b32 v43, 2, v43
    v_lshlrev_b32 v44, 2, v44
    v_lshlrev_b32 v45, 2, v45
    v_lshlrev_b32 v46, 2, v46
    v_lshlrev_b32 v47, 2, v47
    ds_read_b32 v40, v40
    buffer_load_dwordx4 v17, s[20:23], s50 offen offset:1024 lds
    ds_read_b32 v41, v41
    ds_read_b32 v42, v42
    ds_read_b32 v43, v43
    ds_read_b32 v44, v44
    ds_read_b32 v45, v45
    ds_read_b32 v46, v46
    ds_read_b32 v47, v47
    s_waitcnt lgkmcnt(8)
    buffer_load_dwordx4 v18, s[20:23], s50 offen offset:2048 lds
    v_mul_f32 v32, v32, v68
    v_mul_f32 v33, v33, v69
    v_mul_f32 v34, v34, v70
    v_mul_f32 v35, v35, v71
    v_mul_f32 v36, v36, v68
    v_mul_f32 v37, v37, v69
    v_mul_f32 v38, v38, v70
    v_mul_f32 v39, v39, v71
    buffer_load_dwordx4 v19, s[20:23], s50 offen offset:3072 lds
    v_cvt_pk_bf16_f32 v72, v32, v36
    v_cvt_pk_bf16_f32 v76, v33, v37
    v_cvt_pk_bf16_f32 v80, v34, v38
    v_cvt_pk_bf16_f32 v84, v35, v39
    v_lshlrev_b32 v48, 2, v48
    v_lshlrev_b32 v49, 2, v49
    v_lshlrev_b32 v50, 2, v50
    v_lshlrev_b32 v51, 2, v51
    s_add_u32 m0, s46, 69632
    s_nop 0
    v_lshlrev_b32 v52, 2, v52
    v_lshlrev_b32 v53, 2, v53
    v_lshlrev_b32 v54, 2, v54
    v_lshlrev_b32 v55, 2, v55
    ds_read_b32 v48, v48
    ds_read_b32 v49, v49
    ds_read_b32 v50, v50
    ds_read_b32 v51, v51
    buffer_load_dwordx4 v20, s[20:23], s50 offen offset:0 lds
    ds_read_b32 v52, v52
    ds_read_b32 v53, v53
    ds_read_b32 v54, v54
    ds_read_b32 v55, v55
    s_waitcnt lgkmcnt(8)
    v_mul_f32 v40, v40, v68
    v_mul_f32 v41, v41, v69
    v_mul_f32 v42, v42, v70
    buffer_load_dwordx4 v21, s[20:23], s50 offen offset:1024 lds
    v_mul_f32 v43, v43, v71
    v_mul_f32 v44, v44, v68
    v_mul_f32 v45, v45, v69
    v_mul_f32 v46, v46, v70
    v_mul_f32 v47, v47, v71
    v_cvt_pk_bf16_f32 v73, v40, v44
    v_cvt_pk_bf16_f32 v77, v41, v45
    v_cvt_pk_bf16_f32 v81, v42, v46
    buffer_load_dwordx4 v22, s[20:23], s50 offen offset:2048 lds
    v_cvt_pk_bf16_f32 v85, v43, v47
    v_lshlrev_b32 v56, 2, v56
    v_lshlrev_b32 v57, 2, v57
    v_lshlrev_b32 v58, 2, v58
    v_lshlrev_b32 v59, 2, v59
    v_lshlrev_b32 v60, 2, v60
    v_lshlrev_b32 v61, 2, v61
    v_lshlrev_b32 v62, 2, v62
    buffer_load_dwordx4 v23, s[20:23], s50 offen offset:3072 lds
    v_lshlrev_b32 v63, 2, v63
    ds_read_b32 v56, v56
    ds_read_b32 v57, v57
    ds_read_b32 v58, v58
    ds_read_b32 v59, v59
    ds_read_b32 v60, v60
    ds_read_b32 v61, v61
    ds_read_b32 v62, v62
    ds_read_b32 v63, v63
    s_waitcnt lgkmcnt(8)
    v_mul_f32 v48, v48, v68
    v_mul_f32 v49, v49, v69
    v_mul_f32 v50, v50, v70
    v_mul_f32 v51, v51, v71
    v_mul_f32 v52, v52, v68
    v_mul_f32 v53, v53, v69
    v_mul_f32 v54, v54, v70
    v_mul_f32 v55, v55, v71
    v_cvt_pk_bf16_f32 v74, v48, v52
    v_cvt_pk_bf16_f32 v78, v49, v53
    v_cvt_pk_bf16_f32 v82, v50, v54
    v_cvt_pk_bf16_f32 v86, v51, v55
    s_waitcnt lgkmcnt(0)
    v_mul_f32 v56, v56, v68
    v_mul_f32 v57, v57, v69
    v_mul_f32 v58, v58, v70
    v_mul_f32 v59, v59, v71
    v_mul_f32 v60, v60, v68
    v_mul_f32 v61, v61, v69
    v_mul_f32 v62, v62, v70
    v_mul_f32 v63, v63, v71
    v_cvt_pk_bf16_f32 v75, v56, v60
    v_cvt_pk_bf16_f32 v79, v57, v61
    v_cvt_pk_bf16_f32 v83, v58, v62
    v_cvt_pk_bf16_f32 v87, v59, v63
    ds_write_b128 v12, v[72:75] offset:16384
    ds_write_b128 v12, v[76:79] offset:16896
    ds_write_b128 v12, v[80:83] offset:16512
    ds_write_b128 v12, v[84:87] offset:17024
    s_waitcnt vmcnt(8) lgkmcnt(0)
    s_lshl_b32 s45, s70, 3
    s_load_dwordx2 s[64:65], s[54:55], s45 glc
    s_barrier
    s_mov_b32 s45, 41
L_pn:
    v_readfirstlane_b32 s53, v93
    v_readfirstlane_b32 s52, v92
    s_nop 1
    s_cmp_lg_u32 s53, 0
    s_cbranch_scc1 L_pn_ok
    global_load_dwordx2 v[92:93], v90, s[14:15] sc1
    s_waitcnt vmcnt(0)
    s_sub_u32 s45, s45, 1
    s_cmp_lg_u32 s45, 0
    s_cbranch_scc1 L_pn
    s_mov_b32 s52, s60
    s_or_b32 s53, s61, 0x40000000
    v_mov_b32 v92, s52
    v_mov_b32 v93, s53
L_pn_ok:
    s_waitcnt lgkmcnt(0)
    s_cmp_eq_u64 s[64:65], s[52:53]
    s_cbranch_scc1 L_rdy2
    s_mov_b32 s86, s70
    s_mov_b32 s87, 32768
    s_call_b64 s[74:75], L_ensure
    s_cbranch_scc0 L_skip2
L_rdy2:
    s_add_u32 m0, s57, 32768
    s_lshl_b32 s45, s70, 14
    buffer_load_dwordx4 v15, s[36:39], s45 offen offset:0 sc1 lds
    buffer_load_dwordx4 v15, s[36:39], s45 offen offset:1024 sc1 lds
    buffer_load_dwordx4 v15, s[36:39], s45 offen offset:2048 sc1 lds
    buffer_load_dwordx4 v15, s[36:39], s45 offen offset:3072 sc1 lds
L_skip2:
    s_cmp_le_u32 s40, 1
    s_cselect_b32 s71, 2, 1
    s_lshl_b32 s45, s71, 3
    s_load_dwordx2 s[66:67], s[54:55], s45 glc
    s_lshl_b32 s50, s71, 7
    s_add_u32 m0, s46, 0
    s_nop 0
    buffer_load_dwordx4 v16, s[20:23], s50 offen offset:0 lds
    buffer_load_dwordx4 v17, s[20:23], s50 offen offset:1024 lds
    buffer_load_dwordx4 v18, s[20:23], s50 offen offset:2048 lds
    buffer_load_dwordx4 v19, s[20:23], s50 offen offset:3072 lds
    s_add_u32 m0, s46, 4096
    s_nop 0
    buffer_load_dwordx4 v20, s[20:23], s50 offen offset:0 lds
    buffer_load_dwordx4 v21, s[20:23], s50 offen offset:1024 lds
    buffer_load_dwordx4 v22, s[20:23], s50 offen offset:2048 lds
    buffer_load_dwordx4 v23, s[20:23], s50 offen offset:3072 lds
    s_waitcnt lgkmcnt(0)
    s_cmp_eq_u64 s[66:67], s[52:53]
    s_cbranch_scc1 L_rdy3
    s_mov_b32 s86, s71
    s_mov_b32 s87, 0
    s_call_b64 s[74:75], L_ensure
    s_cbranch_scc0 L_skip3
L_rdy3:
    s_add_u32 m0, s57, 0
    s_lshl_b32 s45, s71, 14
    buffer_load_dwordx4 v15, s[36:39], s45 offen offset:0 sc1 lds
    buffer_load_dwordx4 v15, s[36:39], s45 offen offset:1024 sc1 lds
    buffer_load_dwordx4 v15, s[36:39], s45 offen offset:2048 sc1 lds
    buffer_load_dwordx4 v15, s[36:39], s45 offen offset:3072 sc1 lds
L_skip3:
    s_cmp_le_u32 s40, 2
    s_cselect_b32 s70, 3, 2
    s_lshl_b32 s45, s70, 3
    s_load_dwordx2 s[64:65], s[54:55], s45 glc
    buffer_store_dwordx4 v[72:75], v88, s[36:39], 0 offen offset:0 sc1
    s_waitcnt vmcnt(13)
    s_barrier
    s_lshl_b32 s50, s70, 7
    s_add_u32 m0, s46, 32768
    s_nop 0
    buffer_load_dwordx4 v16, s[20:23], s50 offen offset:0 lds
    buffer_load_dwordx4 v17, s[20:23], s50 offen offset:1024 lds
    buffer_load_dwordx4 v18, s[20:23], s50 offen offset:2048 lds
    buffer_load_dwordx4 v19, s[20:23], s50 offen offset:3072 lds
    s_add_u32 m0, s46, 36864
    s_nop 0
    buffer_load_dwordx4 v20, s[20:23], s50 offen offset:0 lds
    buffer_load_dwordx4 v21, s[20:23], s50 offen offset:1024 lds
    buffer_load_dwordx4 v22, s[20:23], s50 offen offset:2048 lds
    buffer_load_dwordx4 v23, s[20:23], s50 offen offset:3072 lds
    s_waitcnt lgkmcnt(0)
    s_cmp_eq_u64 s[64:65], s[52:53]
    s_cbranch_scc1 L_rdy4
    s_mov_b32 s86, s70
    s_mov_b32 s87, 16384
    s_call_b64 s[74:75], L_ensure
    s_cbranch_scc0 L_skip4
L_rdy4:
    s_add_u32 m0, s57, 16384
    s_lshl_b32 s45, s70, 14
    buffer_load_dwordx4 v15, s[36:39], s45 offen offset:0 sc1 lds
    buffer_load_dwordx4 v15, s[36:39], s45 offen offset:1024 sc1 lds
    buffer_load_dwordx4 v15, s[36:39], s45 offen offset:2048 sc1 lds
    buffer_load_dwordx4 v15, s[36:39], s45 offen offset:3072 sc1 lds
L_skip4:
    s_cmp_le_u32 s40, 3
    s_cselect_b32 s71, 4, 3
    s_lshl_b32 s45, s71, 3
    s_load_dwordx2 s[66:67], s[54:55], s45 glc
    buffer_store_dwordx4 v[76:79], v88, s[36:39], 0 offen offset:512 sc1
    s_waitcnt vmcnt(14)
    s_barrier
    s_lshl_b32 s50, s71, 7
    s_add_u32 m0, s46, 65536
    s_nop 0
    buffer_load_dwordx4 v16, s[20:23], s50 offen offset:0 lds
    buffer_load_dwordx4 v17, s[20:23], s50 offen offset:1024 lds
    buffer_load_dwordx4 v18, s[20:23], s50 offen offset:2048 lds
    buffer_load_dwordx4 v19, s[20:23], s50 offen offset:3072 lds
    s_add_u32 m0, s46, 69632
    s_nop 0
    buffer_load_dwordx4 v20, s[20:23], s50 offen offset:0 lds
    buffer_load_dwordx4 v21, s[20:23], s50 offen offset:1024 lds
    buffer_load_dwordx4 v22, s[20:23], s50 offen offset:2048 lds
    buffer_load_dwordx4 v23, s[20:23], s50 offen offset:3072 lds
    s_waitcnt lgkmcnt(0)
    s_cmp_eq_u64 s[66:67], s[52:53]
    s_cbranch_scc1 L_rdy5
    s_mov_b32 s86, s71
    s_mov_b32 s87, 32768
    s_call_b64 s[74:75], L_ensure
    s_cbranch_scc0 L_skip5
L_rdy5:
    s_add_u32 m0, s57, 32768
    s_lshl_b32 s45, s71, 14
    buffer_load_dwordx4 v15, s[36:39], s45 offen offset:0 sc1 lds
    buffer_load_dwordx4 v15, s[36:39], s45 offen offset:1024 sc1 lds
    buffer_load_dwordx4 v15, s[36:39], s45 offen offset:2048 sc1 lds
    buffer_load_dwordx4 v15, s[36:39], s45 offen offset:3072 sc1 lds
L_skip5:
    s_cmp_le_u32 s40, 4
    s_cselect_b32 s70, 5, 4
    s_lshl_b32 s45, s70, 3
    s_load_dwordx2 s[64:65], s[54:55], s45 glc
    buffer_store_dwordx4 v[80:83], v88, s[36:39], 0 offen offset:128 sc1
    s_waitcnt vmcnt(14)
    s_barrier
    s_lshl_b32 s50, s70, 7
    s_add_u32 m0, s46, 0
    s_nop 0
    buffer_load_dwordx4 v16, s[20:23], s50 offen offset:0 lds
    buffer_load_dwordx4 v17, s[20:23], s50 offen offset:1024 lds
    buffer_load_dwordx4 v18, s[20:23], s50 offen offset:2048 lds
    buffer_load_dwordx4 v19, s[20:23], s50 offen offset:3072 lds
    s_add_u32 m0, s46, 4096
    s_nop 0
    buffer_load_dwordx4 v20, s[20:23], s50 offen offset:0 lds
    buffer_load_dwordx4 v21, s[20:23], s50 offen offset:1024 lds
    buffer_load_dwordx4 v22, s[20:23], s50 offen offset:2048 lds
    buffer_load_dwordx4 v23, s[20:23], s50 offen offset:3072 lds
    s_waitcnt lgkmcnt(0)
    s_cmp_eq_u64 s[64:65], s[52:53]
    s_cbranch_scc1 L_rdy6
    s_mov_b32 s86, s70
    s_mov_b32 s87, 0
    s_call_b64 s[74:75], L_ensure
    s_cbranch_scc0 L_skip6
L_rdy6:
    s_add_u32 m0, s57, 0
    s_lshl_b32 s45, s70, 14
    buffer_load_dwordx4 v15, s[36:39], s45 offen offset:0 sc1 lds
    buffer_load_dwordx4 v15, s[36:39], s45 offen offset:1024 sc1 lds
    buffer_load_dwordx4 v15, s[36:39], s45 offen offset:2048 sc1 lds
    buffer_load_dwordx4 v15, s[36:39], s45 offen offset:3072 sc1 lds
L_skip6:
    s_cmp_le_u32 s40, 5
    s_cselect_b32 s71, 6, 5
    s_lshl_b32 s45, s71, 3
    s_load_dwordx2 s[66:67], s[54:55], s45 glc
    buffer_store_dwordx4 v[84:87], v88, s[36:39], 0 offen offset:640 sc1
    s_waitcnt vmcnt(14)
    s_barrier
    s_lshl_b32 s50, s71, 7
    s_add_u32 m0, s46, 32768
    s_nop 0
    buffer_load_dwordx4 v16, s[20:23], s50 offen offset:0 lds
    buffer_load_dwordx4 v17, s[20:23], s50 offen offset:1024 lds
    buffer_load_dwordx4 v18, s[20:23], s50 offen offset:2048 lds
    buffer_load_dwordx4 v19, s[20:23], s50 offen offset:3072 lds
    s_add_u32 m0, s46, 36864
    s_nop 0
    buffer_load_dwordx4 v20, s[20:23], s50 offen offset:0 lds
    buffer_load_dwordx4 v21, s[20:23], s50 offen offset:1024 lds
    buffer_load_dwordx4 v22, s[20:23], s50 offen offset:2048 lds
    buffer_load_dwordx4 v23, s[20:23], s50 offen offset:3072 lds
    s_waitcnt lgkmcnt(0)
    s_cmp_eq_u64 s[66:67], s[52:53]
    s_cbranch_scc1 L_rdy7
    s_mov_b32 s86, s71
    s_mov_b32 s87, 16384
    s_call_b64 s[74:75], L_ensure
    s_cbranch_scc0 L_skip7
L_rdy7:
    s_add_u32 m0, s57, 16384
    s_lshl_b32 s45, s71, 14
    buffer_load_dwordx4 v15, s[36:39], s45 offen offset:0 sc1 lds
    buffer_load_dwordx4 v15, s[36:39], s45 offen offset:1024 sc1 lds
    buffer_load_dwordx4 v15, s[36:39], s45 offen offset:2048 sc1 lds
    buffer_load_dwordx4 v15, s[36:39], s45 offen offset:3072 sc1 lds
L_skip7:
    s_cmp_le_u32 s40, 6
    s_cselect_b32 s70, 7, 6
    s_lshl_b32 s45, s70, 3
    s_load_dwordx2 s[64:65], s[54:55], s45 glc
    s_waitcnt vmcnt(12)
    s_mov_b64 exec, 1
    global_store_dwordx2 v91, v[92:93], s[54:55] sc1
    s_mov_b64 exec, -1
    s_barrier
    s_lshl_b32 s50, s70, 7
    s_add_u32 m0, s46, 65536
    s_nop 0
    buffer_load_dwordx4 v16, s[20:23], s50 offen offset:0 lds
    buffer_load_dwordx4 v17, s[20:23], s50 offen offset:1024 lds
    buffer_load_dwordx4 v18, s[20:23], s50 offen offset:2048 lds
    buffer_load_dwordx4 v19, s[20:23], s50 offen offset:3072 lds
    s_add_u32 m0, s46, 69632
    s_nop 0
    buffer_load_dwordx4 v20, s[20:23], s50 offen offset:0 lds
    buffer_load_dwordx4 v21, s[20:23], s50 offen offset:1024 lds
    buffer_load_dwordx4 v22, s[20:23], s50 offen offset:2048 lds
    buffer_load_dwordx4 v23, s[20:23], s50 offen offset:3072 lds
    s_waitcnt lgkmcnt(0)
    s_cmp_eq_u64 s[64:65], s[52:53]
    s_cbranch_scc1 L_rdy8
    s_mov_b32 s86, s70
    s_mov_b32 s87, 32768
    s_call_b64 s[74:75], L_ensure
    s_cbranch_scc0 L_skip8
L_rdy8:
    s_add_u32 m0, s57, 32768
    s_lshl_b32 s45, s70, 14
    buffer_load_dwordx4 v15, s[36:39], s45 offen offset:0 sc1 lds
    buffer_load_dwordx4 v15, s[36:39], s45 offen offset:1024 sc1 lds
    buffer_load_dwordx4 v15, s[36:39], s45 offen offset:2048 sc1 lds
    buffer_load_dwordx4 v15, s[36:39], s45 offen offset:3072 sc1 lds
L_skip8:
    s_cmp_le_u32 s40, 0
    s_cselect_b32 s71, 9, 8
    s_lshl_b32 s45, s71, 3
    s_load_dwordx2 s[66:67], s[54:55], s45 glc
    s_waitcnt vmcnt(13)
    s_barrier
    s_lshl_b32 s50, s71, 7
    s_add_u32 m0, s46, 0
    s_nop 0
    buffer_load_dwordx4 v16, s[20:23], s50 offen offset:0 lds
    buffer_load_dwordx4 v17, s[20:23], s50 offen offset:1024 lds
    buffer_load_dwordx4 v18, s[20:23], s50 offen offset:2048 lds
    buffer_load_dwordx4 v19, s[20:23], s50 offen offset:3072 lds
    s_add_u32 m0, s46, 4096
    s_nop 0
    buffer_load_dwordx4 v20, s[20:23], s50 offen offset:0 lds
    buffer_load_dwordx4 v21, s[20:23], s50 offen offset:1024 lds
    buffer_load_dwordx4 v22, s[20:23], s50 offen offset:2048 lds
    buffer_load_dwordx4 v23, s[20:23], s50 offen offset:3072 lds
    s_waitcnt lgkmcnt(0)
    s_cmp_eq_u64 s[66:67], s[52:53]
    s_cbranch_scc1 L_rdy9
    s_mov_b32 s86, s71
    s_mov_b32 s87, 0
    s_call_b64 s[74:75], L_ensure
    s_cbranch_scc0 L_skip9
L_rdy9:
    s_add_u32 m0, s57, 0
    s_lshl_b32 s45, s71, 14
    buffer_load_dwordx4 v15, s[36:39], s45 offen offset:0 sc1 lds
    buffer_load_dwordx4 v15, s[36:39], s45 offen offset:1024 sc1 lds
    buffer_load_dwordx4 v15, s[36:39], s45 offen offset:2048 sc1 lds
    buffer_load_dwordx4 v15, s[36:39], s45 offen offset:3072 sc1 lds
L_skip9:
    s_cmp_le_u32 s40, 1
    s_cselect_b32 s70, 10, 9
    s_lshl_b32 s45, s70, 3
    s_load_dwordx2 s[64:65], s[54:55], s45 glc
    s_waitcnt vmcnt(12)
    s_barrier
    s_lshl_b32 s50, s70, 7
    s_add_u32 m0, s46, 32768
    s_nop 0
    buffer_load_dwordx4 v16, s[20:23], s50 offen offset:0 lds
    buffer_load_dwordx4 v17, s[20:23], s50 offen offset:1024 lds
    buffer_load_dwordx4 v18, s[20:23], s50 offen offset:2048 lds
    buffer_load_dwordx4 v19, s[20:23], s50 offen offset:3072 lds
    s_add_u32 m0, s46, 36864
    s_nop 0
    buffer_load_dwordx4 v20, s[20:23], s50 offen offset:0 lds
    buffer_load_dwordx4 v21, s[20:23], s50 offen offset:1024 lds
    buffer_load_dwordx4 v22, s[20:23], s50 offen offset:2048 lds
    buffer_load_dwordx4 v23, s[20:23], s50 offen offset:3072 lds
    s_waitcnt lgkmcnt(0)
    s_cmp_eq_u64 s[64:65], s[52:53]
    s_cbranch_scc1 L_rdy10
    s_mov_b32 s86, s70
    s_mov_b32 s87, 16384
    s_call_b64 s[74:75], L_ensure
    s_cbranch_scc0 L_skip10
L_rdy10:
    s_add_u32 m0, s57, 16384
    s_lshl_b32 s45, s70, 14
    buffer_load_dwordx4 v15, s[36:39], s45 offen offset:0 sc1 lds
    buffer_load_dwordx4 v15, s[36:39], s45 offen offset:1024 sc1 lds
    buffer_load_dwordx4 v15, s[36:39], s45 offen offset:2048 sc1 lds
    buffer_load_dwordx4 v15, s[36:39], s45 offen offset:3072 sc1 lds
L_skip10:
    s_cmp_le_u32 s40, 2
    s_cselect_b32 s71, 11, 10
    s_lshl_b32 s45, s71, 3
    s_load_dwordx2 s[66:67], s[54:55], s45 glc
    s_waitcnt vmcnt(12)
    s_barrier
    s_lshl_b32 s50, s71, 7
    s_add_u32 m0, s46, 65536
    s_nop 0
    buffer_load_dwordx4 v16, s[20:23], s50 offen offset:0 lds
    buffer_load_dwordx4 v17, s[20:23], s50 offen offset:1024 lds
    buffer_load_dwordx4 v18, s[20:23], s50 offen offset:2048 lds
    buffer_load_dwordx4 v19, s[20:23], s50 offen offset:3072 lds
    s_add_u32 m0, s46, 69632
    s_nop 0
    buffer_load_dwordx4 v20, s[20:23], s50 offen offset:0 lds
    buffer_load_dwordx4 v21, s[20:23], s50 offen offset:1024 lds
    buffer_load_dwordx4 v22, s[20:23], s50 offen offset:2048 lds
    buffer_load_dwordx4 v23, s[20:23], s50 offen offset:3072 lds
    s_waitcnt lgkmcnt(0)
    s_cmp_eq_u64 s[66:67], s[52:53]
    s_cbranch_scc1 L_rdy11
    s_mov_b32 s86, s71
    s_mov_b32 s87, 32768
    s_call_b64 s[74:75], L_ensure
    s_cbranch_scc0 L_skip11
L_rdy11:
    s_add_u32 m0, s57, 32768
    s_lshl_b32 s45, s71, 14
    buffer_load_dwordx4 v15, s[36:39], s45 offen offset:0 sc1 lds
    buffer_load_dwordx4 v15, s[36:39], s45 offen offset:1024 sc1 lds
    buffer_load_dwordx4 v15, s[36:39], s45 offen offset:2048 sc1 lds
    buffer_load_dwordx4 v15, s[36:39], s45 offen offset:3072 sc1 lds
L_skip11:
    s_cmp_le_u32 s40, 3
    s_cselect_b32 s70, 12, 11
    s_lshl_b32 s45, s70, 3
    s_load_dwordx2 s[64:65], s[54:55], s45 glc
    s_waitcnt vmcnt(12)
    s_barrier
    s_lshl_b32 s50, s70, 7
    s_add_u32 m0, s46, 0
    s_nop 0
    buffer_load_dwordx4 v16, s[20:23], s50 offen offset:0 lds
    buffer_load_dwordx4 v17, s[20:23], s50 offen offset:1024 lds
    buffer_load_dwordx4 v18, s[20:23], s50 offen offset:2048 lds
    buffer_load_dwordx4 v19, s[20:23], s50 offen offset:3072 lds
    s_add_u32 m0, s46, 4096
    s_nop 0
    buffer_load_dwordx4 v20, s[20:23], s50 offen offset:0 lds
    buffer_load_dwordx4 v21, s[20:23], s50 offen offset:1024 lds
    buffer_load_dwordx4 v22, s[20:23], s50 offen offset:2048 lds
    buffer_load_dwordx4 v23, s[20:23], s50 offen offset:3072 lds
    s_waitcnt lgkmcnt(0)
    s_cmp_eq_u64 s[64:65], s[52:53]
    s_cbranch_scc1 L_rdy12
    s_mov_b32 s86, s70
    s_mov_b32 s87, 0
    s_call_b64 s[74:75], L_ensure
    s_cbranch_scc0 L_skip12
L_rdy12:
    s_add_u32 m0, s57, 0
    s_lshl_b32 s45, s70, 14
    buffer_load_dwordx4 v15, s[36:39], s45 offen offset:0 sc1 lds
    buffer_load_dwordx4 v15, s[36:39], s45 offen offset:1024 sc1 lds
    buffer_load_dwordx4 v15, s[36:39], s45 offen offset:2048 sc1 lds
    buffer_load_dwordx4 v15, s[36:39], s45 offen offset:3072 sc1 lds
L_skip12:
    s_cmp_le_u32 s40, 4
    s_cselect_b32 s71, 13, 12
    s_lshl_b32 s45, s71, 3
    s_load_dwordx2 s[66:67], s[54:55], s45 glc
    s_waitcnt vmcnt(12)
    s_barrier
    s_lshl_b32 s50, s71, 7
    s_add_u32 m0, s46, 32768
    s_nop 0
    buffer_load_dwordx4 v16, s[20:23], s50 offen offset:0 lds
    buffer_load_dwordx4 v17, s[20:23], s50 offen offset:1024 lds
    buffer_load_dwordx4 v18, s[20:23], s50 offen offset:2048 lds
    buffer_load_dwordx4 v19, s[20:23], s50 offen offset:3072 lds
    s_add_u32 m0, s46, 36864
    s_nop 0
    buffer_load_dwordx4 v20, s[20:23], s50 offen offset:0 lds
    buffer_load_dwordx4 v21, s[20:23], s50 offen offset:1024 lds
    buffer_load_dwordx4 v22, s[20:23], s50 offen offset:2048 lds
    buffer_load_dwordx4 v23, s[20:23], s50 offen offset:3072 lds
    s_waitcnt lgkmcnt(0)
    s_cmp_eq_u64 s[66:67], s[52:53]
    s_cbranch_scc1 L_rdy13
    s_mov_b32 s86, s71
    s_mov_b32 s87, 16384
    s_call_b64 s[74:75], L_ensure
    s_cbranch_scc0 L_skip13
L_rdy13:
    s_add_u32 m0, s57, 16384
    s_lshl_b32 s45, s71, 14
    buffer_load_dwordx4 v15, s[36:39], s45 offen offset:0 sc1 lds
    buffer_load_dwordx4 v15, s[36:39], s45 offen offset:1024 sc1 lds
    buffer_load_dwordx4 v15, s[36:39], s45 offen offset:2048 sc1 lds
    buffer_load_dwordx4 v15, s[36:39], s45 offen offset:3072 sc1 lds
L_skip13:
    s_cmp_le_u32 s40, 5
    s_cselect_b32 s70, 14, 13
    s_lshl_b32 s45, s70, 3
    s_load_dwordx2 s[64:65], s[54:55], s45 glc
    s_waitcnt vmcnt(12)
    s_barrier
    s_lshl_b32 s50, s70, 7
    s_add_u32 m0, s46, 65536
    s_nop 0
    buffer_load_dwordx4 v16, s[20:23], s50 offen offset:0 lds
    buffer_load_dwordx4 v17, s[20:23], s50 offen offset:1024 lds
    buffer_load_dwordx4 v18, s[20:23], s50 offen offset:2048 lds
    buffer_load_dwordx4 v19, s[20:23], s50 offen offset:3072 lds
    s_add_u32 m0, s46, 69632
    s_nop 0
    buffer_load_dwordx4 v20, s[20:23], s50 offen offset:0 lds
    buffer_load_dwordx4 v21, s[20:23], s50 offen offset:1024 lds
    buffer_load_dwordx4 v22, s[20:23], s50 offen offset:2048 lds
    buffer_load_dwordx4 v23, s[20:23], s50 offen offset:3072 lds
    s_waitcnt lgkmcnt(0)
    s_cmp_eq_u64 s[64:65], s[52:53]
    s_cbranch_scc1 L_rdy14
    s_mov_b32 s86, s70
    s_mov_b32 s87, 32768
    s_call_b64 s[74:75], L_ensure
    s_cbranch_scc0 L_skip14
L_rdy14:
    s_add_u32 m0, s57, 32768
    s_lshl_b32 s45, s70, 14
    buffer_load_dwordx4 v15, s[36:39], s45 offen offset:0 sc1 lds
    buffer_load_dwordx4 v15, s[36:39], s45 offen offset:1024 sc1 lds
    buffer_load_dwordx4 v15, s[36:39], s45 offen offset:2048 sc1 lds
    buffer_load_dwordx4 v15, s[36:39], s45 offen offset:3072 sc1 lds
L_skip14:
    s_cmp_le_u32 s40, 6
    s_cselect_b32 s71, 15, 14
    s_lshl_b32 s45, s71, 3
    s_load_dwordx2 s[66:67], s[54:55], s45 glc
    s_waitcnt vmcnt(12)
    s_barrier
    s_lshl_b32 s50, s71, 7
    s_add_u32 m0, s46, 0
    s_nop 0
    buffer_load_dwordx4 v16, s[20:23], s50 offen offset:0 lds
    buffer_load_dwordx4 v17, s[20:23], s50 offen offset:1024 lds
    buffer_load_dwordx4 v18, s[20:23], s50 offen offset:2048 lds
    buffer_load_dwordx4 v19, s[20:23], s50 offen offset:3072 lds
    s_add_u32 m0, s46, 4096
    s_nop 0
    buffer_load_dwordx4 v20, s[20:23], s50 offen offset:0 lds
    buffer_load_dwordx4 v21, s[20:23], s50 offen offset:1024 lds
    buffer_load_dwordx4 v22, s[20:23], s50 offen offset:2048 lds
    buffer_load_dwordx4 v23, s[20:23], s50 offen offset:3072 lds
    s_waitcnt lgkmcnt(0)
    s_cmp_eq_u64 s[66:67], s[52:53]
    s_cbranch_scc1 L_rdy15
    s_mov_b32 s86, s71
    s_mov_b32 s87, 0
    s_call_b64 s[74:75], L_ensure
    s_cbranch_scc0 L_skip15
L_rdy15:
    s_add_u32 m0, s57, 0
    s_lshl_b32 s45, s71, 14
    buffer_load_dwordx4 v15, s[36:39], s45 offen offset:0 sc1 lds
    buffer_load_dwordx4 v15, s[36:39], s45 offen offset:1024 sc1 lds
    buffer_load_dwordx4 v15, s[36:39], s45 offen offset:2048 sc1 lds
    buffer_load_dwordx4 v15, s[36:39], s45 offen offset:3072 sc1 lds
L_skip15:
    s_waitcnt vmcnt(12)
    s_barrier
    s_waitcnt vmcnt(0)
    s_barrier
    s_endpgm
L_ensure:
    s_mov_b32 s91, 40
    s_lshl_b32 s88, s86, 3
L_poll:
    s_load_dwordx2 s[92:93], s[54:55], s88 glc
    s_waitcnt lgkmcnt(0)
    s_cmp_eq_u64 s[92:93], s[52:53]
    s_cbranch_scc1 L_ret
    s_sub_u32 s91, s91, 1
    s_cmp_lg_u32 s91, 0
    s_cbranch_scc1 L_poll
    s_mul_i32 s59, s86, 7168
    s_mul_i32 s56, s86, 917504
    buffer_load_dwordx4 v[96:99], v10, s[24:27], s56 offen
    s_add_u32 s56, s56, 14336
    buffer_load_dwordx4 v[100:103], v10, s[24:27], s56 offen
    s_add_u32 s56, s56, 14336
    buffer_load_dwordx4 v[104:107], v10, s[24:27], s56 offen
    s_add_u32 s56, s56, 14336
    buffer_load_dwordx4 v[108:111], v10, s[24:27], s56 offen
    s_add_u32 s56, s56, 14336
    buffer_load_dwordx4 v[112:115], v10, s[24:27], s56 offen
    s_add_u32 s56, s56, 14336
    buffer_load_dwordx4 v[116:119], v10, s[24:27], s56 offen
    s_add_u32 s56, s56, 14336
    buffer_load_dwordx4 v[120:123], v10, s[24:27], s56 offen
    s_add_u32 s56, s56, 14336
    buffer_load_dwordx4 v[124:127], v10, s[24:27], s56 offen
    buffer_load_dwordx2 v[128:129], v11, s[28:31], s59 offen
    v_add_u32 v241, s87, v12
    s_waitcnt vmcnt(0)
    v_lshlrev_b32 v96, 2, v96
    v_lshlrev_b32 v97, 2, v97
    v_lshlrev_b32 v98, 2, v98
    v_lshlrev_b32 v99, 2, v99
    v_lshlrev_b32 v100, 2, v100
    v_lshlrev_b32 v101, 2, v101
    v_lshlrev_b32 v102, 2, v102
    v_lshlrev_b32 v103, 2, v103
    ds_read_b32 v96, v96
    ds_read_b32 v97, v97
    ds_read_b32 v98, v98
    ds_read_b32 v99, v99
    ds_read_b32 v100, v100
    ds_read_b32 v101, v101
    ds_read_b32 v102, v102
    ds_read_b32 v103, v103
    v_lshlrev_b32 v132, 16, v128
    v_and_b32 v133, 0xffff0000, v128
    v_lshlrev_b32 v134, 16, v129
    v_and_b32 v135, 0xffff0000, v129
    v_lshlrev_b32 v104, 2, v104
    v_lshlrev_b32 v105, 2, v105
    v_lshlrev_b32 v106, 2, v106
    v_lshlrev_b32 v107, 2, v107
    v_lshlrev_b32 v108, 2, v108
    v_lshlrev_b32 v109, 2, v109
    v_lshlrev_b32 v110, 2, v110
    v_lshlrev_b32 v111, 2, v111
    ds_read_b32 v104, v104
    ds_read_b32 v105, v105
    ds_read_b32 v106, v106
    ds_read_b32 v107, v107
    ds_read_b32 v108, v108
    ds_read_b32 v109, v109
    ds_read_b32 v110, v110
    ds_read_b32 v111, v111
    s_waitcnt lgkmcnt(8)
    v_mul_f32 v96, v96, v132
    v_mul_f32 v97, v97, v133
    v_mul_f32 v98, v98, v134
    v_mul_f32 v99, v99, v135
    v_mul_f32 v100, v100, v132
    v_mul_f32 v101, v101, v133
    v_mul_f32 v102, v102, v134
    v_mul_f32 v103, v103, v135
    v_cvt_pk_bf16_f32 v136, v96, v100
    v_cvt_pk_bf16_f32 v140, v97, v101
    v_cvt_pk_bf16_f32 v144, v98, v102
    v_cvt_pk_bf16_f32 v148, v99, v103
    v_lshlrev_b32 v112, 2, v112
    v_lshlrev_b32 v113, 2, v113
    v_lshlrev_b32 v114, 2, v114
    v_lshlrev_b32 v115, 2, v115
    v_lshlrev_b32 v116, 2, v116
    v_lshlrev_b32 v117, 2, v117
    v_lshlrev_b32 v118, 2, v118
    v_lshlrev_b32 v119, 2, v119
    ds_read_b32 v112, v112
    ds_read_b32 v113, v113
    ds_read_b32 v114, v114
    ds_read_b32 v115, v115
    ds_read_b32 v116, v116
    ds_read_b32 v117, v117
    ds_read_b32 v118, v118
    ds_read_b32 v119, v119
    s_waitcnt lgkmcnt(8)
    v_mul_f32 v104, v104, v132
    v_mul_f32 v105, v105, v133
    v_mul_f32 v106, v106, v134
    v_mul_f32 v107, v107, v135
    v_mul_f32 v108, v108, v132
    v_mul_f32 v109, v109, v133
    v_mul_f32 v110, v110, v134
    v_mul_f32 v111, v111, v135
    v_cvt_pk_bf16_f32 v137, v104, v108
    v_cvt_pk_bf16_f32 v141, v105, v109
    v_cvt_pk_bf16_f32 v145, v106, v110
    v_cvt_pk_bf16_f32 v149, v107, v111
    v_lshlrev_b32 v120, 2, v120
    v_lshlrev_b32 v121, 2, v121
    v_lshlrev_b32 v122, 2, v122
    v_lshlrev_b32 v123, 2, v123
    v_lshlrev_b32 v124, 2, v124
    v_lshlrev_b32 v125, 2, v125
    v_lshlrev_b32 v126, 2, v126
    v_lshlrev_b32 v127, 2, v127
    ds_read_b32 v120, v120
    ds_read_b32 v121, v121
    ds_read_b32 v122, v122
    ds_read_b32 v123, v123
    ds_read_b32 v124, v124
    ds_read_b32 v125, v125
    ds_read_b32 v126, v126
    ds_read_b32 v127, v127
    s_waitcnt lgkmcnt(8)
    v_mul_f32 v112, v112, v132
    v_mul_f32 v113, v113, v133
    v_mul_f32 v114, v114, v134
    v_mul_f32 v115, v115, v135
    v_mul_f32 v116, v116, v132
    v_mul_f32 v117, v117, v133
    v_mul_f32 v118, v118, v134
    v_mul_f32 v119, v119, v135
    v_cvt_pk_bf16_f32 v138, v112, v116
    v_cvt_pk_bf16_f32 v142, v113, v117
    v_cvt_pk_bf16_f32 v146, v114, v118
    v_cvt_pk_bf16_f32 v150, v115, v119
    s_waitcnt lgkmcnt(0)
    v_mul_f32 v120, v120, v132
    v_mul_f32 v121, v121, v133
    v_mul_f32 v122, v122, v134
    v_mul_f32 v123, v123, v135
    v_mul_f32 v124, v124, v132
    v_mul_f32 v125, v125, v133
    v_mul_f32 v126, v126, v134
    v_mul_f32 v127, v127, v135
    v_cvt_pk_bf16_f32 v139, v120, v124
    v_cvt_pk_bf16_f32 v143, v121, v125
    v_cvt_pk_bf16_f32 v147, v122, v126
    v_cvt_pk_bf16_f32 v151, v123, v127
    ds_write_b128 v241, v[136:139] offset:0
    ds_write_b128 v241, v[140:143] offset:512
    ds_write_b128 v241, v[144:147] offset:128
    ds_write_b128 v241, v[148:151] offset:640
    s_waitcnt lgkmcnt(0)
    s_cmp_lg_u32 s45, s45
L_ret:
    s_setpc_b64 s[74:75]
L_cons2:
    v_lshrrev_b32 v7, 3, v3
    v_lshlrev_b32 v7, 10, v7
    v_and_b32 v8, 7, v3
    v_lshl_add_u32 v7, v8, 4, v7
    v_lshl_add_u32 v12, v4, 8, v7
    v_lshlrev_b32 v14, 1, v6
    s_lshl_b32 s45, s41, 4
    s_add_u32 s45, s45, s40
    s_lshl_b32 s45, s45, 2
    s_add_u32 s45, s45, s43
    s_lshl_b32 s45, s45, 12
    v_add_u32 v72, s45, v12
    s_lshl_b32 s45, s41, 2
    s_add_u32 s45, s45, s43
    s_lshl_b32 s45, s45, 7
    s_add_u32 s45, s45, 8388608
    s_add_u32 s54, s36, s45
    s_addc_u32 s55, s37, 0
    s_lshl_b32 s45, s40, 3
    v_mov_b32 v225, s45
    v_mov_b32 v224, 0
    s_lshl_b32 s45, s43, 12
    s_add_u32 s57, s45, 99328
    v_add_u32 v12, s57, v12
    s_lshl_b32 s44, s40, 8
    s_lshl_b32 s45, s43, 6
    s_add_u32 s44, s44, s45
    v_lshrrev_b32 v1, 4, v0
    v_and_b32 v73, 15, v0
    v_lshrrev_b32 v15, 1, v73
    v_xor_b32 v15, v15, v1
    v_lshlrev_b32 v15, 4, v15
    v_lshl_add_u32 v15, v73, 7, v15
    s_lshl_b32 s45, s43, 13
    s_add_u32 s45, s45, 1024
    v_add_u32 v2, s45, v15
    v_xor_b32 v3, 64, v2
    v_add_u32 v4, 0x10000, v2
    v_add_u32 v5, 0x10000, v3
    v_lshrrev_b32 v15, 1, v73
    v_and_b32 v7, 1, v73
    v_lshl_add_u32 v15, v7, 3, v15
    v_lshlrev_b32 v15, 4, v15
    v_and_b32 v7, 1, v1
    v_lshl_add_u32 v15, v7, 8, v15
    v_lshrrev_b32 v7, 1, v1
    v_lshl_add_u32 v15, v7, 12, v15
    v_add_u32 v6, 99328, v15
    v_lshlrev_b32 v15, 2, v1
    v_add_u32 v15, s44, v15
    v_mul_u32_u24 v15, 7168, v15
    v_lshl_add_u32 v15, v73, 2, v15
    s_mul_i32 s45, s47, 448
    v_add_u32 v15, s45, v15
    v_add_u32 v8, 192, v15
    s_lshl_b32 s45, s42, 8
    v_add_u32 v7, s45, v15
    s_mul_i32 s48, s42, 229376
    s_sub_u32 s49, 229376, s48
    s_mov_b32 s32, s12
    s_mov_b32 s33, s13
    s_mov_b32 s34, 14680064
    s_mov_b32 s35, 0x20000
    s_lshl_b32 s45, s41, 3
    s_lshl_b32 s50, s40, 8
    s_add_u32 s45, s45, s50
    s_lshl_b32 s50, s43, 1
    s_add_u32 s45, s45, s50
    v_lshrrev_b32 v228, 5, v0
    v_add_u32 v228, s45, v228
    v_lshlrev_b32 v228, 11, v228
    v_and_b32 v15, 31, v0
    v_lshl_add_u32 v228, v15, 6, v228
    s_waitcnt vmcnt(0)
    v_lshlrev_b32 v13, 16, v13
    ds_write_b32 v14, v13
    v_lshlrev_b32 v16, 2, v16
    v_lshlrev_b32 v17, 2, v17
    v_lshlrev_b32 v18, 2, v18
    v_lshlrev_b32 v19, 2, v19
    v_lshlrev_b32 v20, 2, v20
    v_lshlrev_b32 v21, 2, v21
    v_lshlrev_b32 v22, 2, v22
    v_lshlrev_b32 v23, 2, v23
    ds_read_b32 v16, v16
    ds_read_b32 v17, v17
    ds_read_b32 v18, v18
    ds_read_b32 v19, v19
    ds_read_b32 v20, v20
    ds_read_b32 v21, v21
    ds_read_b32 v22, v22
    ds_read_b32 v23, v23
    v_lshlrev_b32 v52, 16, v48
    v_and_b32 v53, 0xffff0000, v48
    v_lshlrev_b32 v54, 16, v49
    v_and_b32 v55, 0xffff0000, v49
    v_lshlrev_b32 v24, 2, v24
    v_lshlrev_b32 v25, 2, v25
    v_lshlrev_b32 v26, 2, v26
    v_lshlrev_b32 v27, 2, v27
    v_lshlrev_b32 v28, 2, v28
    v_lshlrev_b32 v29, 2, v29
    v_lshlrev_b32 v30, 2, v30
    v_lshlrev_b32 v31, 2, v31
    ds_read_b32 v24, v24
    ds_read_b32 v25, v25
    ds_read_b32 v26, v26
    ds_read_b32 v27, v27
    ds_read_b32 v28, v28
    ds_read_b32 v29, v29
    ds_read_b32 v30, v30
    ds_read_b32 v31, v31
    s_waitcnt lgkmcnt(8)
    v_mul_f32 v16, v16, v52
    v_mul_f32 v17, v17, v53
    v_mul_f32 v18, v18, v54
    v_mul_f32 v19, v19, v55
    v_mul_f32 v20, v20, v52
    v_mul_f32 v21, v21, v53
    v_mul_f32 v22, v22, v54
    v_mul_f32 v23, v23, v55
    v_cvt_pk_bf16_f32 v56, v16, v20
    v_cvt_pk_bf16_f32 v60, v17, v21
    v_cvt_pk_bf16_f32 v64, v18, v22
    v_cvt_pk_bf16_f32 v68, v19, v23
    v_lshlrev_b32 v32, 2, v32
    v_lshlrev_b32 v33, 2, v33
    v_lshlrev_b32 v34, 2, v34
    v_lshlrev_b32 v35, 2, v35
    v_lshlrev_b32 v36, 2, v36
    v_lshlrev_b32 v37, 2, v37
    v_lshlrev_b32 v38, 2, v38
    v_lshlrev_b32 v39, 2, v39
    ds_read_b32 v32, v32
    ds_read_b32 v33, v33
    ds_read_b32 v34, v34
    ds_read_b32 v35, v35
    ds_read_b32 v36, v36
    ds_read_b32 v37, v37
    ds_read_b32 v38, v38
    ds_read_b32 v39, v39
    s_waitcnt lgkmcnt(8)
    v_mul_f32 v24, v24, v52
    v_mul_f32 v25, v25, v53
    v_mul_f32 v26, v26, v54
    v_mul_f32 v27, v27, v55
    v_mul_f32 v28, v28, v52
    v_mul_f32 v29, v29, v53
    v_mul_f32 v30, v30, v54
    v_mul_f32 v31, v31, v55
    v_cvt_pk_bf16_f32 v57, v24, v28
    v_cvt_pk_bf16_f32 v61, v25, v29
    v_cvt_pk_bf16_f32 v65, v26, v30
    v_cvt_pk_bf16_f32 v69, v27, v31
    v_lshlrev_b32 v40, 2, v40
    v_lshlrev_b32 v41, 2, v41
    v_lshlrev_b32 v42, 2, v42
    v_lshlrev_b32 v43, 2, v43
    v_lshlrev_b32 v44, 2, v44
    v_lshlrev_b32 v45, 2, v45
    v_lshlrev_b32 v46, 2, v46
    v_lshlrev_b32 v47, 2, v47
    ds_read_b32 v40, v40
    ds_read_b32 v41, v41
    ds_read_b32 v42, v42
    ds_read_b32 v43, v43
    ds_read_b32 v44, v44
    ds_read_b32 v45, v45
    ds_read_b32 v46, v46
    ds_read_b32 v47, v47
    s_waitcnt lgkmcnt(8)
    v_mul_f32 v32, v32, v52
    v_mul_f32 v33, v33, v53
    v_mul_f32 v34, v34, v54
    v_mul_f32 v35, v35, v55
    v_mul_f32 v36, v36, v52
    v_mul_f32 v37, v37, v53
    v_mul_f32 v38, v38, v54
    v_mul_f32 v39, v39, v55
    v_cvt_pk_bf16_f32 v58, v32, v36
    v_cvt_pk_bf16_f32 v62, v33, v37
    v_cvt_pk_bf16_f32 v66, v34, v38
    v_cvt_pk_bf16_f32 v70, v35, v39
    s_waitcnt lgkmcnt(0)
    v_mul_f32 v40, v40, v52
    v_mul_f32 v41, v41, v53
    v_mul_f32 v42, v42, v54
    v_mul_f32 v43, v43, v55
    v_mul_f32 v44, v44, v52
    v_mul_f32 v45, v45, v53
    v_mul_f32 v46, v46, v54
    v_mul_f32 v47, v47, v55
    v_cvt_pk_bf16_f32 v59, v40, v44
    v_cvt_pk_bf16_f32 v63, v41, v45
    v_cvt_pk_bf16_f32 v67, v42, v46
    v_cvt_pk_bf16_f32 v71, v43, v47
    buffer_store_dwordx4 v[56:59], v72, s[36:39], 0 offen offset:0 sc1
    buffer_store_dwordx4 v[60:63], v72, s[36:39], 0 offen offset:512 sc1
    buffer_store_dwordx4 v[64:67], v72, s[36:39], 0 offen offset:128 sc1
    buffer_store_dwordx4 v[68:71], v72, s[36:39], 0 offen offset:640 sc1
    ds_write_b128 v12, v[56:59] offset:0
    ds_write_b128 v12, v[60:63] offset:512
    ds_write_b128 v12, v[64:67] offset:128
    ds_write_b128 v12, v[68:71] offset:640
    global_load_dwordx2 v[226:227], v224, s[14:15] sc1
    s_waitcnt lgkmcnt(0)
    s_barrier
    ds_read_b128 v[192:195], v6 offset:3072
    ds_read_b128 v[196:199], v6 offset:11264
    ds_read_b128 v[128:131], v2 offset:0
    ds_read_b128 v[132:135], v3 offset:0
    ds_read_b128 v[136:139], v2 offset:2048
    ds_read_b128 v[140:143], v3 offset:2048
    ds_read_b128 v[144:147], v2 offset:4096
    ds_read_b128 v[148:151], v3 offset:4096
    ds_read_b128 v[152:155], v2 offset:6144
    ds_read_b128 v[156:159], v3 offset:6144
    ds_read_b128 v[200:203], v6 offset:3584
    ds_read_b128 v[204:207], v6 offset:11776
    ds_read_b128 v[208:211], v6 offset:0
    ds_read_b128 v[212:215], v6 offset:8192
    s_waitcnt lgkmcnt(8)
    v_mfma_f32_16x16x32_bf16 v[112:115], v[128:131], v[192:195], 0
    ds_read_b128 v[216:219], v6 offset:512
    v_mfma_f32_16x16x32_bf16 v[112:115], v[132:135], v[196:199], v[112:115]
    ds_read_b128 v[220:223], v6 offset:8704
    v_mfma_f32_16x16x32_bf16 v[116:119], v[140:143], v[196:199], 0
    v_mfma_f32_16x16x32_bf16 v[116:119], v[136:139], v[192:195], v[116:119]
    s_waitcnt lgkmcnt(4)
    v_mfma_f32_16x16x32_bf16 v[124:127], v[136:139], v[200:203], 0
    ds_read_b128 v[192:195], v6 offset:1024
    v_mfma_f32_16x16x32_bf16 v[124:127], v[140:143], v[204:207], v[124:127]
    ds_read_b128 v[196:199], v6 offset:9216
    v_mfma_f32_16x16x32_bf16 v[120:123], v[132:135], v[204:207], 0
    v_mfma_f32_16x16x32_bf16 v[120:123], v[128:131], v[200:203], v[120:123]
    s_waitcnt lgkmcnt(4)
    v_mfma_f32_16x16x32_bf16 v[16:19], v[128:131], v[208:211], 0
    ds_read_b128 v[200:203], v6 offset:1536
    v_mfma_f32_16x16x32_bf16 v[16:19], v[132:135], v[212:215], v[16:19]
    ds_read_b128 v[204:207], v6 offset:9728
    v_mfma_f32_16x16x32_bf16 v[20:23], v[140:143], v[212:215], 0
    v_mfma_f32_16x16x32_bf16 v[20:23], v[136:139], v[208:211], v[20:23]
    v_mfma_f32_16x16x32_bf16 v[24:27], v[144:147], v[208:211], 0
    v_mfma_f32_16x16x32_bf16 v[24:27], v[148:151], v[212:215], v[24:27]
    v_mfma_f32_16x16x32_bf16 v[28:31], v[156:159], v[212:215], 0
    v_mfma_f32_16x16x32_bf16 v[28:31], v[152:155], v[208:211], v[28:31]
    s_waitcnt lgkmcnt(4)
    v_mfma_f32_16x16x32_bf16 v[44:47], v[152:155], v[216:219], 0
    ds_read_b128 v[208:211], v6 offset:2048
    v_mfma_f32_16x16x32_bf16 v[44:47], v[156:159], v[220:223], v[44:47]
    ds_read_b128 v[212:215], v6 offset:10240
    v_mfma_f32_16x16x32_bf16 v[40:43], v[148:151], v[220:223], 0
    v_mfma_f32_16x16x32_bf16 v[40:43], v[144:147], v[216:219], v[40:43]
    v_mfma_f32_16x16x32_bf16 v[36:39], v[136:139], v[216:219], 0
    v_mfma_f32_16x16x32_bf16 v[36:39], v[140:143], v[220:223], v[36:39]
    v_mfma_f32_16x16x32_bf16 v[32:35], v[132:135], v[220:223], 0
    v_mfma_f32_16x16x32_bf16 v[32:35], v[128:131], v[216:219], v[32:35]
    s_waitcnt lgkmcnt(4)
    v_mfma_f32_16x16x32_bf16 v[48:51], v[128:131], v[192:195], 0
    ds_read_b128 v[216:219], v6 offset:2560
    v_mfma_f32_16x16x32_bf16 v[48:51], v[132:135], v[196:199], v[48:51]
    ds_read_b128 v[220:223], v6 offset:10752
    v_mfma_f32_16x16x32_bf16 v[52:55], v[140:143], v[196:199], 0
    v_mfma_f32_16x16x32_bf16 v[52:55], v[136:139], v[192:195], v[52:55]
    v_mfma_f32_16x16x32_bf16 v[56:59], v[144:147], v[192:195], 0
    v_mfma_f32_16x16x32_bf16 v[56:59], v[148:151], v[196:199], v[56:59]
    v_mfma_f32_16x16x32_bf16 v[60:63], v[156:159], v[196:199], 0
    v_mfma_f32_16x16x32_bf16 v[60:63], v[152:155], v[192:195], v[60:63]
    s_waitcnt lgkmcnt(4)
    v_mfma_f32_16x16x32_bf16 v[76:79], v[152:155], v[200:203], 0
    v_mfma_f32_16x16x32_bf16 v[76:79], v[156:159], v[204:207], v[76:79]
    v_mfma_f32_16x16x32_bf16 v[72:75], v[148:151], v[204:207], 0
    v_mfma_f32_16x16x32_bf16 v[72:75], v[144:147], v[200:203], v[72:75]
    v_mfma_f32_16x16x32_bf16 v[68:71], v[136:139], v[200:203], 0
    v_mfma_f32_16x16x32_bf16 v[68:71], v[140:143], v[204:207], v[68:71]
    v_mfma_f32_16x16x32_bf16 v[64:67], v[132:135], v[204:207], 0
    v_mfma_f32_16x16x32_bf16 v[64:67], v[128:131], v[200:203], v[64:67]
    s_waitcnt lgkmcnt(2)
    v_mfma_f32_16x16x32_bf16 v[80:83], v[128:131], v[208:211], 0
    v_mfma_f32_16x16x32_bf16 v[80:83], v[132:135], v[212:215], v[80:83]
    v_mfma_f32_16x16x32_bf16 v[84:87], v[140:143], v[212:215], 0
    v_mfma_f32_16x16x32_bf16 v[84:87], v[136:139], v[208:211], v[84:87]
    v_mfma_f32_16x16x32_bf16 v[88:91], v[144:147], v[208:211], 0
    v_mfma_f32_16x16x32_bf16 v[88:91], v[148:151], v[212:215], v[88:91]
    v_mfma_f32_16x16x32_bf16 v[92:95], v[156:159], v[212:215], 0
    v_mfma_f32_16x16x32_bf16 v[92:95], v[152:155], v[208:211], v[92:95]
    s_waitcnt lgkmcnt(0)
    v_mfma_f32_16x16x32_bf16 v[108:111], v[152:155], v[216:219], 0
    v_mfma_f32_16x16x32_bf16 v[108:111], v[156:159], v[220:223], v[108:111]
    v_mfma_f32_16x16x32_bf16 v[104:107], v[148:151], v[220:223], 0
    v_mfma_f32_16x16x32_bf16 v[104:107], v[144:147], v[216:219], v[104:107]
    v_mfma_f32_16x16x32_bf16 v[100:103], v[136:139], v[216:219], 0
    v_mfma_f32_16x16x32_bf16 v[100:103], v[140:143], v[220:223], v[100:103]
    v_mfma_f32_16x16x32_bf16 v[96:99], v[132:135], v[220:223], 0
    v_mfma_f32_16x16x32_bf16 v[96:99], v[128:131], v[216:219], v[96:99]
    s_waitcnt vmcnt(0)
    s_mov_b32 s45, 41
L_cn:
    v_readfirstlane_b32 s53, v227
    v_readfirstlane_b32 s52, v226
    s_nop 1
    s_cmp_lg_u32 s53, 0
    s_cbranch_scc1 L_cn_ok
    global_load_dwordx2 v[226:227], v224, s[14:15] sc1
    s_waitcnt vmcnt(0)
    s_sub_u32 s45, s45, 1
    s_cmp_lg_u32 s45, 0
    s_cbranch_scc1 L_cn
    s_mov_b32 s52, s60
    s_or_b32 s53, s61, 0x40000000
    v_mov_b32 v226, s52
    v_mov_b32 v227, s53
L_cn_ok:
    s_mov_b64 exec, 1
    global_store_dwordx2 v225, v[226:227], s[54:55] sc1
    s_mov_b64 exec, -1
    s_lshl_b32 s45, s40, 1
    s_lshl_b32 s45, 0x10001, s45
    s_cmp_eq_u32 s40, 0
    s_cselect_b32 s50, 4, 1
    s_or_b32 s45, s45, s50
    s_andn2_b32 exec_lo, 0x55555555, s45
    s_mov_b32 exec_hi, exec_lo
    buffer_load_dword v229, v228, s[20:23], 0 offen
    s_mov_b64 exec, -1
    s_barrier
    ds_read_b128 v[192:195], v6 offset:19456
    ds_read_b128 v[196:199], v6 offset:27648
    ds_read_b128 v[160:163], v2 offset:32768
    ds_read_b128 v[164:167], v3 offset:32768
    ds_read_b128 v[168:171], v2 offset:34816
    ds_read_b128 v[172:175], v3 offset:34816
    ds_read_b128 v[176:179], v2 offset:36864
    ds_read_b128 v[180:183], v3 offset:36864
    ds_read_b128 v[184:187], v2 offset:38912
    ds_read_b128 v[188:191], v3 offset:38912
    ds_read_b128 v[200:203], v6 offset:19968
    ds_read_b128 v[204:207], v6 offset:28160
    ds_read_b128 v[208:211], v6 offset:16384
    ds_read_b128 v[212:215], v6 offset:24576
    s_waitcnt lgkmcnt(8)
    v_mfma_f32_16x16x32_bf16 v[112:115], v[160:163], v[192:195], v[112:115]
    ds_read_b128 v[216:219], v6 offset:16896
    v_mfma_f32_16x16x32_bf16 v[112:115], v[164:167], v[196:199], v[112:115]
    ds_read_b128 v[220:223], v6 offset:25088
    v_mfma_f32_16x16x32_bf16 v[116:119], v[172:175], v[196:199], v[116:119]
    v_mfma_f32_16x16x32_bf16 v[116:119], v[168:171], v[192:195], v[116:119]
    s_waitcnt lgkmcnt(4)
    v_mfma_f32_16x16x32_bf16 v[124:127], v[168:171], v[200:203], v[124:127]
    ds_read_b128 v[192:195], v6 offset:17408
    v_mfma_f32_16x16x32_bf16 v[124:127], v[172:175], v[204:207], v[124:127]
    ds_read_b128 v[196:199], v6 offset:25600
    v_mfma_f32_16x16x32_bf16 v[120:123], v[164:167], v[204:207], v[120:123]
    v_mfma_f32_16x16x32_bf16 v[120:123], v[160:163], v[200:203], v[120:123]
    s_waitcnt lgkmcnt(4)
    v_mfma_f32_16x16x32_bf16 v[16:19], v[160:163], v[208:211], v[16:19]
    ds_read_b128 v[200:203], v6 offset:17920
    v_mfma_f32_16x16x32_bf16 v[16:19], v[164:167], v[212:215], v[16:19]
    ds_read_b128 v[204:207], v6 offset:26112
    v_mfma_f32_16x16x32_bf16 v[20:23], v[172:175], v[212:215], v[20:23]
    v_mfma_f32_16x16x32_bf16 v[20:23], v[168:171], v[208:211], v[20:23]
    v_mfma_f32_16x16x32_bf16 v[24:27], v[176:179], v[208:211], v[24:27]
    v_mfma_f32_16x16x32_bf16 v[24:27], v[180:183], v[212:215], v[24:27]
    v_mfma_f32_16x16x32_bf16 v[28:31], v[188:191], v[212:215], v[28:31]
    v_mfma_f32_16x16x32_bf16 v[28:31], v[184:187], v[208:211], v[28:31]
    s_waitcnt lgkmcnt(4)
    v_mfma_f32_16x16x32_bf16 v[44:47], v[184:187], v[216:219], v[44:47]
    ds_read_b128 v[208:211], v6 offset:18432
    v_mfma_f32_16x16x32_bf16 v[44:47], v[188:191], v[220:223], v[44:47]
    ds_read_b128 v[212:215], v6 offset:26624
    v_mfma_f32_16x16x32_bf16 v[40:43], v[180:183], v[220:223], v[40:43]
    v_mfma_f32_16x16x32_bf16 v[40:43], v[176:179], v[216:219], v[40:43]
    v_mfma_f32_16x16x32_bf16 v[36:39], v[168:171], v[216:219], v[36:39]
    v_mfma_f32_16x16x32_bf16 v[36:39], v[172:175], v[220:223], v[36:39]
    v_mfma_f32_16x16x32_bf16 v[32:35], v[164:167], v[220:223], v[32:35]
    v_mfma_f32_16x16x32_bf16 v[32:35], v[160:163], v[216:219], v[32:35]
    s_waitcnt lgkmcnt(4)
    v_mfma_f32_16x16x32_bf16 v[48:51], v[160:163], v[192:195], v[48:51]
    ds_read_b128 v[216:219], v6 offset:18944
    v_mfma_f32_16x16x32_bf16 v[48:51], v[164:167], v[196:199], v[48:51]
    ds_read_b128 v[220:223], v6 offset:27136
    v_mfma_f32_16x16x32_bf16 v[52:55], v[172:175], v[196:199], v[52:55]
    v_mfma_f32_16x16x32_bf16 v[52:55], v[168:171], v[192:195], v[52:55]
    v_mfma_f32_16x16x32_bf16 v[56:59], v[176:179], v[192:195], v[56:59]
    v_mfma_f32_16x16x32_bf16 v[56:59], v[180:183], v[196:199], v[56:59]
    v_mfma_f32_16x16x32_bf16 v[60:63], v[188:191], v[196:199], v[60:63]
    v_mfma_f32_16x16x32_bf16 v[60:63], v[184:187], v[192:195], v[60:63]
    s_branch L_fin1
    .p2align 12
L_stub1:
    s_setpc_b64 s[74:75]
    s_nop 0
L_fin1:
    s_waitcnt lgkmcnt(0)
    s_barrier
    v_mfma_f32_16x16x32_bf16 v[76:79], v[184:187], v[200:203], v[76:79]
    ds_read_b128 v[192:195], v6 offset:35840
    v_mfma_f32_16x16x32_bf16 v[76:79], v[188:191], v[204:207], v[76:79]
    ds_read_b128 v[196:199], v6 offset:44032
    v_mfma_f32_16x16x32_bf16 v[72:75], v[180:183], v[204:207], v[72:75]
    ds_read_b128 v[128:131], v4 offset:0
    v_mfma_f32_16x16x32_bf16 v[72:75], v[176:179], v[200:203], v[72:75]
    ds_read_b128 v[132:135], v5 offset:0
    v_mfma_f32_16x16x32_bf16 v[68:71], v[168:171], v[200:203], v[68:71]
    ds_read_b128 v[136:139], v4 offset:2048
    v_mfma_f32_16x16x32_bf16 v[68:71], v[172:175], v[204:207], v[68:71]
    ds_read_b128 v[140:143], v5 offset:2048
    v_mfma_f32_16x16x32_bf16 v[64:67], v[164:167], v[204:207], v[64:67]
    v_mfma_f32_16x16x32_bf16 v[64:67], v[160:163], v[200:203], v[64:67]
    v_mfma_f32_16x16x32_bf16 v[80:83], v[160:163], v[208:211], v[80:83]
    ds_read_b128 v[200:203], v6 offset:36352
    v_mfma_f32_16x16x32_bf16 v[80:83], v[164:167], v[212:215], v[80:83]
    ds_read_b128 v[204:207], v6 offset:44544
    v_mfma_f32_16x16x32_bf16 v[84:87], v[172:175], v[212:215], v[84:87]
    ds_read_b128 v[144:147], v4 offset:4096
    v_mfma_f32_16x16x32_bf16 v[84:87], v[168:171], v[208:211], v[84:87]
    ds_read_b128 v[148:151], v5 offset:4096
    v_mfma_f32_16x16x32_bf16 v[88:91], v[176:179], v[208:211], v[88:91]
    ds_read_b128 v[152:155], v4 offset:6144
    v_mfma_f32_16x16x32_bf16 v[88:91], v[180:183], v[212:215], v[88:91]
    ds_read_b128 v[156:159], v5 offset:6144
    v_mfma_f32_16x16x32_bf16 v[92:95], v[188:191], v[212:215], v[92:95]
    v_mfma_f32_16x16x32_bf16 v[92:95], v[184:187], v[208:211], v[92:95]
    v_mfma_f32_16x16x32_bf16 v[108:111], v[184:187], v[216:219], v[108:111]
    ds_read_b128 v[208:211], v6 offset:32768
    v_mfma_f32_16x16x32_bf16 v[108:111], v[188:191], v[220:223], v[108:111]
    ds_read_b128 v[212:215], v6 offset:40960
    v_mfma_f32_16x16x32_bf16 v[104:107], v[180:183], v[220:223], v[104:107]
    v_mfma_f32_16x16x32_bf16 v[104:107], v[176:179], v[216:219], v[104:107]
    v_mfma_f32_16x16x32_bf16 v[100:103], v[168:171], v[216:219], v[100:103]
    v_mfma_f32_16x16x32_bf16 v[100:103], v[172:175], v[220:223], v[100:103]
    v_mfma_f32_16x16x32_bf16 v[96:99], v[164:167], v[220:223], v[96:99]
    v_mfma_f32_16x16x32_bf16 v[96:99], v[160:163], v[216:219], v[96:99]
    s_waitcnt lgkmcnt(8)
    v_mfma_f32_16x16x32_bf16 v[112:115], v[128:131], v[192:195], v[112:115]
    ds_read_b128 v[216:219], v6 offset:33280
    v_mfma_f32_16x16x32_bf16 v[112:115], v[132:135], v[196:199], v[112:115]
    ds_read_b128 v[220:223], v6 offset:41472
    v_mfma_f32_16x16x32_bf16 v[116:119], v[140:143], v[196:199], v[116:119]
    v_mfma_f32_16x16x32_bf16 v[116:119], v[136:139], v[192:195], v[116:119]
    s_waitcnt lgkmcnt(8)
    v_mfma_f32_16x16x32_bf16 v[124:127], v[136:139], v[200:203], v[124:127]
    ds_read_b128 v[192:195], v6 offset:33792
    v_mfma_f32_16x16x32_bf16 v[124:127], v[140:143], v[204:207], v[124:127]
    ds_read_b128 v[196:199], v6 offset:41984
    v_mfma_f32_16x16x32_bf16 v[120:123], v[132:135], v[204:207], v[120:123]
    v_mfma_f32_16x16x32_bf16 v[120:123], v[128:131], v[200:203], v[120:123]
    s_waitcnt lgkmcnt(4)
    v_mfma_f32_16x16x32_bf16 v[16:19], v[128:131], v[208:211], v[16:19]
    ds_read_b128 v[200:203], v6 offset:34304
    v_mfma_f32_16x16x32_bf16 v[16:19], v[132:135], v[212:215], v[16:19]
    ds_read_b128 v[204:207], v6 offset:42496
    v_mfma_f32_16x16x32_bf16 v[20:23], v[140:143], v[212:215], v[20:23]
    v_mfma_f32_16x16x32_bf16 v[20:23], v[136:139], v[208:211], v[20:23]
    v_mfma_f32_16x16x32_bf16 v[24:27], v[144:147], v[208:211], v[24:27]
    v_mfma_f32_16x16x32_bf16 v[24:27], v[148:151], v[212:215], v[24:27]
    v_mfma_f32_16x16x32_bf16 v[28:31], v[156:159], v[212:215], v[28:31]
    v_mfma_f32_16x16x32_bf16 v[28:31], v[152:155], v[208:211], v[28:31]
    s_waitcnt lgkmcnt(4)
    v_mfma_f32_16x16x32_bf16 v[44:47], v[152:155], v[216:219], v[44:47]
    ds_read_b128 v[208:211], v6 offset:34816
    v_mfma_f32_16x16x32_bf16 v[44:47], v[156:159], v[220:223], v[44:47]
    ds_read_b128 v[212:215], v6 offset:43008
    v_mfma_f32_16x16x32_bf16 v[40:43], v[148:151], v[220:223], v[40:43]
    v_mfma_f32_16x16x32_bf16 v[40:43], v[144:147], v[216:219], v[40:43]
    v_mfma_f32_16x16x32_bf16 v[36:39], v[136:139], v[216:219], v[36:39]
    v_mfma_f32_16x16x32_bf16 v[36:39], v[140:143], v[220:223], v[36:39]
    v_mfma_f32_16x16x32_bf16 v[32:35], v[132:135], v[220:223], v[32:35]
    v_mfma_f32_16x16x32_bf16 v[32:35], v[128:131], v[216:219], v[32:35]
    s_waitcnt lgkmcnt(4)
    v_mfma_f32_16x16x32_bf16 v[48:51], v[128:131], v[192:195], v[48:51]
    ds_read_b128 v[216:219], v6 offset:35328
    v_mfma_f32_16x16x32_bf16 v[48:51], v[132:135], v[196:199], v[48:51]
    ds_read_b128 v[220:223], v6 offset:43520
    v_mfma_f32_16x16x32_bf16 v[52:55], v[140:143], v[196:199], v[52:55]
    v_mfma_f32_16x16x32_bf16 v[52:55], v[136:139], v[192:195], v[52:55]
    v_mfma_f32_16x16x32_bf16 v[56:59], v[144:147], v[192:195], v[56:59]
    v_mfma_f32_16x16x32_bf16 v[56:59], v[148:151], v[196:199], v[56:59]
    v_mfma_f32_16x16x32_bf16 v[60:63], v[156:159], v[196:199], v[60:63]
    v_mfma_f32_16x16x32_bf16 v[60:63], v[152:155], v[192:195], v[60:63]
    s_waitcnt lgkmcnt(0)
    s_barrier
    v_mfma_f32_16x16x32_bf16 v[76:79], v[152:155], v[200:203], v[76:79]
    ds_read_b128 v[192:195], v6 offset:3072
    v_mfma_f32_16x16x32_bf16 v[76:79], v[156:159], v[204:207], v[76:79]
    ds_read_b128 v[196:199], v6 offset:11264
    v_mfma_f32_16x16x32_bf16 v[72:75], v[148:151], v[204:207], v[72:75]
    ds_read_b128 v[160:163], v2 offset:0
    v_mfma_f32_16x16x32_bf16 v[72:75], v[144:147], v[200:203], v[72:75]
    ds_read_b128 v[164:167], v3 offset:0
    v_mfma_f32_16x16x32_bf16 v[68:71], v[136:139], v[200:203], v[68:71]
    ds_read_b128 v[168:171], v2 offset:2048
    v_mfma_f32_16x16x32_bf16 v[68:71], v[140:143], v[204:207], v[68:71]
    ds_read_b128 v[172:175], v3 offset:2048
    v_mfma_f32_16x16x32_bf16 v[64:67], v[132:135], v[204:207], v[64:67]
    v_mfma_f32_16x16x32_bf16 v[64:67], v[128:131], v[200:203], v[64:67]
    v_mfma_f32_16x16x32_bf16 v[80:83], v[128:131], v[208:211], v[80:83]
    ds_read_b128 v[200:203], v6 offset:3584
    v_mfma_f32_16x16x32_bf16 v[80:83], v[132:135], v[212:215], v[80:83]
    ds_read_b128 v[204:207], v6 offset:11776
    v_mfma_f32_16x16x32_bf16 v[84:87], v[140:143], v[212:215], v[84:87]
    ds_read_b128 v[176:179], v2 offset:4096
    v_mfma_f32_16x16x32_bf16 v[84:87], v[136:139], v[208:211], v[84:87]
    ds_read_b128 v[180:183], v3 offset:4096
    v_mfma_f32_16x16x32_bf16 v[88:91], v[144:147], v[208:211], v[88:91]
    ds_read_b128 v[184:187], v2 offset:6144
    v_mfma_f32_16x16x32_bf16 v[88:91], v[148:151], v[212:215], v[88:91]
    ds_read_b128 v[188:191], v3 offset:6144
    v_mfma_f32_16x16x32_bf16 v[92:95], v[156:159], v[212:215], v[92:95]
    v_mfma_f32_16x16x32_bf16 v[92:95], v[152:155], v[208:211], v[92:95]
    v_mfma_f32_16x16x32_bf16 v[108:111], v[152:155], v[216:219], v[108:111]
    ds_read_b128 v[208:211], v6 offset:0
    v_mfma_f32_16x16x32_bf16 v[108:111], v[156:159], v[220:223], v[108:111]
    ds_read_b128 v[212:215], v6 offset:8192
    v_mfma_f32_16x16x32_bf16 v[104:107], v[148:151], v[220:223], v[104:107]
    v_mfma_f32_16x16x32_bf16 v[104:107], v[144:147], v[216:219], v[104:107]
    v_mfma_f32_16x16x32_bf16 v[100:103], v[136:139], v[216:219], v[100:103]
    v_mfma_f32_16x16x32_bf16 v[100:103], v[140:143], v[220:223], v[100:103]
    v_mfma_f32_16x16x32_bf16 v[96:99], v[132:135], v[220:223], v[96:99]
    v_mfma_f32_16x16x32_bf16 v[96:99], v[128:131], v[216:219], v[96:99]
    s_waitcnt lgkmcnt(8)
    v_mfma_f32_16x16x32_bf16 v[112:115], v[160:163], v[192:195], v[112:115]
    ds_read_b128 v[216:219], v6 offset:512
    v_mfma_f32_16x16x32_bf16 v[112:115], v[164:167], v[196:199], v[112:115]
    ds_read_b128 v[220:223], v6 offset:8704
    v_mfma_f32_16x16x32_bf16 v[116:119], v[172:175], v[196:199], v[116:119]
    v_mfma_f32_16x16x32_bf16 v[116:119], v[168:171], v[192:195], v[116:119]
    s_waitcnt lgkmcnt(8)
    v_mfma_f32_16x16x32_bf16 v[124:127], v[168:171], v[200:203], v[124:127]
    ds_read_b128 v[192:195], v6 offset:1024
    v_mfma_f32_16x16x32_bf16 v[124:127], v[172:175], v[204:207], v[124:127]
    ds_read_b128 v[196:199], v6 offset:9216
    v_mfma_f32_16x16x32_bf16 v[120:123], v[164:167], v[204:207], v[120:123]
    v_mfma_f32_16x16x32_bf16 v[120:123], v[160:163], v[200:203], v[120:123]
    s_waitcnt lgkmcnt(4)
    v_mfma_f32_16x16x32_bf16 v[16:19], v[160:163], v[208:211], v[16:19]
    ds_read_b128 v[200:203], v6 offset:1536
    v_mfma_f32_16x16x32_bf16 v[16:19], v[164:167], v[212:215], v[16:19]
    ds_read_b128 v[204:207], v6 offset:9728
    v_mfma_f32_16x16x32_bf16 v[20:23], v[172:175], v[212:215], v[20:23]
    v_mfma_f32_16x16x32_bf16 v[20:23], v[168:171], v[208:211], v[20:23]
    v_mfma_f32_16x16x32_bf16 v[24:27], v[176:179], v[208:211], v[24:27]
    v_mfma_f32_16x16x32_bf16 v[24:27], v[180:183], v[212:215], v[24:27]
    v_mfma_f32_16x16x32_bf16 v[28:31], v[188:191], v[212:215], v[28:31]
    v_mfma_f32_16x16x32_bf16 v[28:31], v[184:187], v[208:211], v[28:31]
    s_waitcnt lgkmcnt(4)
    v_mfma_f32_16x16x32_bf16 v[44:47], v[184:187], v[216:219], v[44:47]
    ds_read_b128 v[208:211], v6 offset:2048
    v_mfma_f32_16x16x32_bf16 v[44:47], v[188:191], v[220:223], v[44:47]
    ds_read_b128 v[212:215], v6 offset:10240
    v_mfma_f32_16x16x32_bf16 v[40:43], v[180:183], v[220:223], v[40:43]
    v_mfma_f32_16x16x32_bf16 v[40:43], v[176:179], v[216:219], v[40:43]
    v_mfma_f32_16x16x32_bf16 v[36:39], v[168:171], v[216:219], v[36:39]
    v_mfma_f32_16x16x32_bf16 v[36:39], v[172:175], v[220:223], v[36:39]
    v_mfma_f32_16x16x32_bf16 v[32:35], v[164:167], v[220:223], v[32:35]
    v_mfma_f32_16x16x32_bf16 v[32:35], v[160:163], v[216:219], v[32:35]
    s_waitcnt lgkmcnt(4)
    v_mfma_f32_16x16x32_bf16 v[48:51], v[160:163], v[192:195], v[48:51]
    ds_read_b128 v[216:219], v6 offset:2560
    v_mfma_f32_16x16x32_bf16 v[48:51], v[164:167], v[196:199], v[48:51]
    ds_read_b128 v[220:223], v6 offset:10752
    v_mfma_f32_16x16x32_bf16 v[52:55], v[172:175], v[196:199], v[52:55]
    v_mfma_f32_16x16x32_bf16 v[52:55], v[168:171], v[192:195], v[52:55]
    v_mfma_f32_16x16x32_bf16 v[56:59], v[176:179], v[192:195], v[56:59]
    v_mfma_f32_16x16x32_bf16 v[56:59], v[180:183], v[196:199], v[56:59]
    v_mfma_f32_16x16x32_bf16 v[60:63], v[188:191], v[196:199], v[60:63]
    v_mfma_f32_16x16x32_bf16 v[60:63], v[184:187], v[192:195], v[60:63]
    s_waitcnt lgkmcnt(0)
    s_barrier
    v_mfma_f32_16x16x32_bf16 v[76:79], v[184:187], v[200:203], v[76:79]
    ds_read_b128 v[192:195], v6 offset:19456
    v_mfma_f32_16x16x32_bf16 v[76:79], v[188:191], v[204:207], v[76:79]
    ds_read_b128 v[196:199], v6 offset:27648
    v_mfma_f32_16x16x32_bf16 v[72:75], v[180:183], v[204:207], v[72:75]
    ds_read_b128 v[128:131], v2 offset:32768
    v_mfma_f32_16x16x32_bf16 v[72:75], v[176:179], v[200:203], v[72:75]
    ds_read_b128 v[132:135], v3 offset:32768
    v_mfma_f32_16x16x32_bf16 v[68:71], v[168:171], v[200:203], v[68:71]
    ds_read_b128 v[136:139], v2 offset:34816
    v_mfma_f32_16x16x32_bf16 v[68:71], v[172:175], v[204:207], v[68:71]
    ds_read_b128 v[140:143], v3 offset:34816
    v_mfma_f32_16x16x32_bf16 v[64:67], v[164:167], v[204:207], v[64:67]
    v_mfma_f32_16x16x32_bf16 v[64:67], v[160:163], v[200:203], v[64:67]
    v_mfma_f32_16x16x32_bf16 v[80:83], v[160:163], v[208:211], v[80:83]
    ds_read_b128 v[200:203], v6 offset:19968
    v_mfma_f32_16x16x32_bf16 v[80:83], v[164:167], v[212:215], v[80:83]
    ds_read_b128 v[204:207], v6 offset:28160
    v_mfma_f32_16x16x32_bf16 v[84:87], v[172:175], v[212:215], v[84:87]
    ds_read_b128 v[144:147], v2 offset:36864
    v_mfma_f32_16x16x32_bf16 v[84:87], v[168:171], v[208:211], v[84:87]
    ds_read_b128 v[148:151], v3 offset:36864
    v_mfma_f32_16x16x32_bf16 v[88:91], v[176:179], v[208:211], v[88:91]
    ds_read_b128 v[152:155], v2 offset:38912
    v_mfma_f32_16x16x32_bf16 v[88:91], v[180:183], v[212:215], v[88:91]
    ds_read_b128 v[156:159], v3 offset:38912
    v_mfma_f32_16x16x32_bf16 v[92:95], v[188:191], v[212:215], v[92:95]
    v_mfma_f32_16x16x32_bf16 v[92:95], v[184:187], v[208:211], v[92:95]
    v_mfma_f32_16x16x32_bf16 v[108:111], v[184:187], v[216:219], v[108:111]
    ds_read_b128 v[208:211], v6 offset:16384
    v_mfma_f32_16x16x32_bf16 v[108:111], v[188:191], v[220:223], v[108:111]
    ds_read_b128 v[212:215], v6 offset:24576
    v_mfma_f32_16x16x32_bf16 v[104:107], v[180:183], v[220:223], v[104:107]
    v_mfma_f32_16x16x32_bf16 v[104:107], v[176:179], v[216:219], v[104:107]
    v_mfma_f32_16x16x32_bf16 v[100:103], v[168:171], v[216:219], v[100:103]
    v_mfma_f32_16x16x32_bf16 v[100:103], v[172:175], v[220:223], v[100:103]
    v_mfma_f32_16x16x32_bf16 v[96:99], v[164:167], v[220:223], v[96:99]
    v_mfma_f32_16x16x32_bf16 v[96:99], v[160:163], v[216:219], v[96:99]
    s_waitcnt lgkmcnt(8)
    v_mfma_f32_16x16x32_bf16 v[112:115], v[128:131], v[192:195], v[112:115]
    ds_read_b128 v[216:219], v6 offset:16896
    v_mfma_f32_16x16x32_bf16 v[112:115], v[132:135], v[196:199], v[112:115]
    ds_read_b128 v[220:223], v6 offset:25088
    v_mfma_f32_16x16x32_bf16 v[116:119], v[140:143], v[196:199], v[116:119]
    v_mfma_f32_16x16x32_bf16 v[116:119], v[136:139], v[192:195], v[116:119]
    s_waitcnt lgkmcnt(8)
    v_mfma_f32_16x16x32_bf16 v[124:127], v[136:139], v[200:203], v[124:127]
    ds_read_b128 v[192:195], v6 offset:17408
    v_mfma_f32_16x16x32_bf16 v[124:127], v[140:143], v[204:207], v[124:127]
    ds_read_b128 v[196:199], v6 offset:25600
    v_mfma_f32_16x16x32_bf16 v[120:123], v[132:135], v[204:207], v[120:123]
    v_mfma_f32_16x16x32_bf16 v[120:123], v[128:131], v[200:203], v[120:123]
    s_waitcnt lgkmcnt(4)
    v_mfma_f32_16x16x32_bf16 v[16:19], v[128:131], v[208:211], v[16:19]
    ds_read_b128 v[200:203], v6 offset:17920
    v_mfma_f32_16x16x32_bf16 v[16:19], v[132:135], v[212:215], v[16:19]
    ds_read_b128 v[204:207], v6 offset:26112
    v_mfma_f32_16x16x32_bf16 v[20:23], v[140:143], v[212:215], v[20:23]
    v_mfma_f32_16x16x32_bf16 v[20:23], v[136:139], v[208:211], v[20:23]
    v_mfma_f32_16x16x32_bf16 v[24:27], v[144:147], v[208:211], v[24:27]
    v_mfma_f32_16x16x32_bf16 v[24:27], v[148:151], v[212:215], v[24:27]
    v_mfma_f32_16x16x32_bf16 v[28:31], v[156:159], v[212:215], v[28:31]
    v_mfma_f32_16x16x32_bf16 v[28:31], v[152:155], v[208:211], v[28:31]
    s_waitcnt lgkmcnt(4)
    v_mfma_f32_16x16x32_bf16 v[44:47], v[152:155], v[216:219], v[44:47]
    ds_read_b128 v[208:211], v6 offset:18432
    v_mfma_f32_16x16x32_bf16 v[44:47], v[156:159], v[220:223], v[44:47]
    ds_read_b128 v[212:215], v6 offset:26624
    v_mfma_f32_16x16x32_bf16 v[40:43], v[148:151], v[220:223], v[40:43]
    v_mfma_f32_16x16x32_bf16 v[40:43], v[144:147], v[216:219], v[40:43]
    v_mfma_f32_16x16x32_bf16 v[36:39], v[136:139], v[216:219], v[36:39]
    v_mfma_f32_16x16x32_bf16 v[36:39], v[140:143], v[220:223], v[36:39]
    v_mfma_f32_16x16x32_bf16 v[32:35], v[132:135], v[220:223], v[32:35]
    v_mfma_f32_16x16x32_bf16 v[32:35], v[128:131], v[216:219], v[32:35]
    s_waitcnt lgkmcnt(4)
    v_mfma_f32_16x16x32_bf16 v[48:51], v[128:131], v[192:195], v[48:51]
    ds_read_b128 v[216:219], v6 offset:18944
    v_mfma_f32_16x16x32_bf16 v[48:51], v[132:135], v[196:199], v[48:51]
    ds_read_b128 v[220:223], v6 offset:27136
    v_mfma_f32_16x16x32_bf16 v[52:55], v[140:143], v[196:199], v[52:55]
    v_mfma_f32_16x16x32_bf16 v[52:55], v[136:139], v[192:195], v[52:55]
    v_mfma_f32_16x16x32_bf16 v[56:59], v[144:147], v[192:195], v[56:59]
    v_mfma_f32_16x16x32_bf16 v[56:59], v[148:151], v[196:199], v[56:59]
    v_mfma_f32_16x16x32_bf16 v[60:63], v[156:159], v[196:199], v[60:63]
    v_mfma_f32_16x16x32_bf16 v[60:63], v[152:155], v[192:195], v[60:63]
    s_waitcnt lgkmcnt(0)
    s_barrier
    v_mfma_f32_16x16x32_bf16 v[76:79], v[152:155], v[200:203], v[76:79]
    ds_read_b128 v[192:195], v6 offset:35840
    v_mfma_f32_16x16x32_bf16 v[76:79], v[156:159], v[204:207], v[76:79]
    ds_read_b128 v[196:199], v6 offset:44032
    v_mfma_f32_16x16x32_bf16 v[72:75], v[148:151], v[204:207], v[72:75]
    ds_read_b128 v[160:163], v4 offset:0
    v_mfma_f32_16x16x32_bf16 v[72:75], v[144:147], v[200:203], v[72:75]
    ds_read_b128 v[164:167], v5 offset:0
    v_mfma_f32_16x16x32_bf16 v[68:71], v[136:139], v[200:203], v[68:71]
    ds_read_b128 v[168:171], v4 offset:2048
    v_mfma_f32_16x16x32_bf16 v[68:71], v[140:143], v[204:207], v[68:71]
    ds_read_b128 v[172:175], v5 offset:2048
    v_mfma_f32_16x16x32_bf16 v[64:67], v[132:135], v[204:207], v[64:67]
    v_mfma_f32_16x16x32_bf16 v[64:67], v[128:131], v[200:203], v[64:67]
    v_mfma_f32_16x16x32_bf16 v[80:83], v[128:131], v[208:211], v[80:83]
    ds_read_b128 v[200:203], v6 offset:36352
    v_mfma_f32_16x16x32_bf16 v[80:83], v[132:135], v[212:215], v[80:83]
    ds_read_b128 v[204:207], v6 offset:44544
    v_mfma_f32_16x16x32_bf16 v[84:87], v[140:143], v[212:215], v[84:87]
    ds_read_b128 v[176:179], v4 offset:4096
    v_mfma_f32_16x16x32_bf16 v[84:87], v[136:139], v[208:211], v[84:87]
    ds_read_b128 v[180:183], v5 offset:4096
    v_mfma_f32_16x16x32_bf16 v[88:91], v[144:147], v[208:211], v[88:91]
    ds_read_b128 v[184:187], v4 offset:6144
    v_mfma_f32_16x16x32_bf16 v[88:91], v[148:151], v[212:215], v[88:91]
    ds_read_b128 v[188:191], v5 offset:6144
    v_mfma_f32_16x16x32_bf16 v[92:95], v[156:159], v[212:215], v[92:95]
    v_mfma_f32_16x16x32_bf16 v[92:95], v[152:155], v[208:211], v[92:95]
    v_mfma_f32_16x16x32_bf16 v[108:111], v[152:155], v[216:219], v[108:111]
    ds_read_b128 v[208:211], v6 offset:32768
    v_mfma_f32_16x16x32_bf16 v[108:111], v[156:159], v[220:223], v[108:111]
    ds_read_b128 v[212:215], v6 offset:40960
    v_mfma_f32_16x16x32_bf16 v[104:107], v[148:151], v[220:223], v[104:107]
    v_mfma_f32_16x16x32_bf16 v[104:107], v[144:147], v[216:219], v[104:107]
    v_mfma_f32_16x16x32_bf16 v[100:103], v[136:139], v[216:219], v[100:103]
    v_mfma_f32_16x16x32_bf16 v[100:103], v[140:143], v[220:223], v[100:103]
    v_mfma_f32_16x16x32_bf16 v[96:99], v[132:135], v[220:223], v[96:99]
    v_mfma_f32_16x16x32_bf16 v[96:99], v[128:131], v[216:219], v[96:99]
    s_waitcnt lgkmcnt(8)
    v_mfma_f32_16x16x32_bf16 v[112:115], v[160:163], v[192:195], v[112:115]
    ds_read_b128 v[216:219], v6 offset:33280
    v_mfma_f32_16x16x32_bf16 v[112:115], v[164:167], v[196:199], v[112:115]
    ds_read_b128 v[220:223], v6 offset:41472
    v_mfma_f32_16x16x32_bf16 v[116:119], v[172:175], v[196:199], v[116:119]
    v_mfma_f32_16x16x32_bf16 v[116:119], v[168:171], v[192:195], v[116:119]
    s_waitcnt lgkmcnt(8)
    v_mfma_f32_16x16x32_bf16 v[124:127], v[168:171], v[200:203], v[124:127]
    ds_read_b128 v[192:195], v6 offset:33792
    v_mfma_f32_16x16x32_bf16 v[124:127], v[172:175], v[204:207], v[124:127]
    ds_read_b128 v[196:199], v6 offset:41984
    v_mfma_f32_16x16x32_bf16 v[120:123], v[164:167], v[204:207], v[120:123]
    v_mfma_f32_16x16x32_bf16 v[120:123], v[160:163], v[200:203], v[120:123]
    s_waitcnt lgkmcnt(4)
    v_mfma_f32_16x16x32_bf16 v[16:19], v[160:163], v[208:211], v[16:19]
    ds_read_b128 v[200:203], v6 offset:34304
    v_mfma_f32_16x16x32_bf16 v[16:19], v[164:167], v[212:215], v[16:19]
    ds_read_b128 v[204:207], v6 offset:42496
    v_mfma_f32_16x16x32_bf16 v[20:23], v[172:175], v[212:215], v[20:23]
    v_mfma_f32_16x16x32_bf16 v[20:23], v[168:171], v[208:211], v[20:23]
    v_mfma_f32_16x16x32_bf16 v[24:27], v[176:179], v[208:211], v[24:27]
    v_mfma_f32_16x16x32_bf16 v[24:27], v[180:183], v[212:215], v[24:27]
    v_mfma_f32_16x16x32_bf16 v[28:31], v[188:191], v[212:215], v[28:31]
    v_mfma_f32_16x16x32_bf16 v[28:31], v[184:187], v[208:211], v[28:31]
    s_waitcnt lgkmcnt(4)
    v_mfma_f32_16x16x32_bf16 v[44:47], v[184:187], v[216:219], v[44:47]
    ds_read_b128 v[208:211], v6 offset:34816
    v_mfma_f32_16x16x32_bf16 v[44:47], v[188:191], v[220:223], v[44:47]
    ds_read_b128 v[212:215], v6 offset:43008
    v_mfma_f32_16x16x32_bf16 v[40:43], v[180:183], v[220:223], v[40:43]
    v_mfma_f32_16x16x32_bf16 v[40:43], v[176:179], v[216:219], v[40:43]
    v_mfma_f32_16x16x32_bf16 v[36:39], v[168:171], v[216:219], v[36:39]
    v_mfma_f32_16x16x32_bf16 v[36:39], v[172:175], v[220:223], v[36:39]
    v_mfma_f32_16x16x32_bf16 v[32:35], v[164:167], v[220:223], v[32:35]
    v_mfma_f32_16x16x32_bf16 v[32:35], v[160:163], v[216:219], v[32:35]
    s_waitcnt lgkmcnt(4)
    v_mfma_f32_16x16x32_bf16 v[48:51], v[160:163], v[192:195], v[48:51]
    ds_read_b128 v[216:219], v6 offset:35328
    v_mfma_f32_16x16x32_bf16 v[48:51], v[164:167], v[196:199], v[48:51]
    ds_read_b128 v[220:223], v6 offset:43520
    v_mfma_f32_16x16x32_bf16 v[52:55], v[172:175], v[196:199], v[52:55]
    v_mfma_f32_16x16x32_bf16 v[52:55], v[168:171], v[192:195], v[52:55]
    v_mfma_f32_16x16x32_bf16 v[56:59], v[176:179], v[192:195], v[56:59]
    v_mfma_f32_16x16x32_bf16 v[56:59], v[180:183], v[196:199], v[56:59]
    v_mfma_f32_16x16x32_bf16 v[60:63], v[188:191], v[196:199], v[60:63]
    v_mfma_f32_16x16x32_bf16 v[60:63], v[184:187], v[192:195], v[60:63]
    s_waitcnt lgkmcnt(0)
    s_barrier
    v_mfma_f32_16x16x32_bf16 v[76:79], v[184:187], v[200:203], v[76:79]
    ds_read_b128 v[192:195], v6 offset:3072
    v_mfma_f32_16x16x32_bf16 v[76:79], v[188:191], v[204:207], v[76:79]
    ds_read_b128 v[196:199], v6 offset:11264
    v_mfma_f32_16x16x32_bf16 v[72:75], v[180:183], v[204:207], v[72:75]
    ds_read_b128 v[128:131], v2 offset:0
    v_mfma_f32_16x16x32_bf16 v[72:75], v[176:179], v[200:203], v[72:75]
    ds_read_b128 v[132:135], v3 offset:0
    v_mfma_f32_16x16x32_bf16 v[68:71], v[168:171], v[200:203], v[68:71]
    ds_read_b128 v[136:139], v2 offset:2048
    v_mfma_f32_16x16x32_bf16 v[68:71], v[172:175], v[204:207], v[68:71]
    ds_read_b128 v[140:143], v3 offset:2048
    v_mfma_f32_16x16x32_bf16 v[64:67], v[164:167], v[204:207], v[64:67]
    v_mfma_f32_16x16x32_bf16 v[64:67], v[160:163], v[200:203], v[64:67]
    v_mfma_f32_16x16x32_bf16 v[80:83], v[160:163], v[208:211], v[80:83]
    ds_read_b128 v[200:203], v6 offset:3584
    v_mfma_f32_16x16x32_bf16 v[80:83], v[164:167], v[212:215], v[80:83]
    ds_read_b128 v[204:207], v6 offset:11776
    v_mfma_f32_16x16x32_bf16 v[84:87], v[172:175], v[212:215], v[84:87]
    ds_read_b128 v[144:147], v2 offset:4096
    v_mfma_f32_16x16x32_bf16 v[84:87], v[168:171], v[208:211], v[84:87]
    ds_read_b128 v[148:151], v3 offset:4096
    v_mfma_f32_16x16x32_bf16 v[88:91], v[176:179], v[208:211], v[88:91]
    ds_read_b128 v[152:155], v2 offset:6144
    v_mfma_f32_16x16x32_bf16 v[88:91], v[180:183], v[212:215], v[88:91]
    ds_read_b128 v[156:159], v3 offset:6144
    v_mfma_f32_16x16x32_bf16 v[92:95], v[188:191], v[212:215], v[92:95]
    v_mfma_f32_16x16x32_bf16 v[92:95], v[184:187], v[208:211], v[92:95]
    v_mfma_f32_16x16x32_bf16 v[108:111], v[184:187], v[216:219], v[108:111]
    ds_read_b128 v[208:211], v6 offset:0
    v_mfma_f32_16x16x32_bf16 v[108:111], v[188:191], v[220:223], v[108:111]
    ds_read_b128 v[212:215], v6 offset:8192
    v_mfma_f32_16x16x32_bf16 v[104:107], v[180:183], v[220:223], v[104:107]
    v_mfma_f32_16x16x32_bf16 v[104:107], v[176:179], v[216:219], v[104:107]
    v_mfma_f32_16x16x32_bf16 v[100:103], v[168:171], v[216:219], v[100:103]
    v_mfma_f32_16x16x32_bf16 v[100:103], v[172:175], v[220:223], v[100:103]
    v_mfma_f32_16x16x32_bf16 v[96:99], v[164:167], v[220:223], v[96:99]
    v_mfma_f32_16x16x32_bf16 v[96:99], v[160:163], v[216:219], v[96:99]
    s_waitcnt lgkmcnt(8)
    v_mfma_f32_16x16x32_bf16 v[112:115], v[128:131], v[192:195], v[112:115]
    ds_read_b128 v[216:219], v6 offset:512
    v_mfma_f32_16x16x32_bf16 v[112:115], v[132:135], v[196:199], v[112:115]
    ds_read_b128 v[220:223], v6 offset:8704
    v_mfma_f32_16x16x32_bf16 v[116:119], v[140:143], v[196:199], v[116:119]
    v_mfma_f32_16x16x32_bf16 v[116:119], v[136:139], v[192:195], v[116:119]
    s_waitcnt lgkmcnt(8)
    v_mfma_f32_16x16x32_bf16 v[124:127], v[136:139], v[200:203], v[124:127]
    ds_read_b128 v[192:195], v6 offset:1024
    v_mfma_f32_16x16x32_bf16 v[124:127], v[140:143], v[204:207], v[124:127]
    ds_read_b128 v[196:199], v6 offset:9216
    v_mfma_f32_16x16x32_bf16 v[120:123], v[132:135], v[204:207], v[120:123]
    v_mfma_f32_16x16x32_bf16 v[120:123], v[128:131], v[200:203], v[120:123]
    s_waitcnt lgkmcnt(4)
    v_mfma_f32_16x16x32_bf16 v[16:19], v[128:131], v[208:211], v[16:19]
    ds_read_b128 v[200:203], v6 offset:1536
    v_mfma_f32_16x16x32_bf16 v[16:19], v[132:135], v[212:215], v[16:19]
    ds_read_b128 v[204:207], v6 offset:9728
    v_mfma_f32_16x16x32_bf16 v[20:23], v[140:143], v[212:215], v[20:23]
    v_mfma_f32_16x16x32_bf16 v[20:23], v[136:139], v[208:211], v[20:23]
    v_mfma_f32_16x16x32_bf16 v[24:27], v[144:147], v[208:211], v[24:27]
    v_mfma_f32_16x16x32_bf16 v[24:27], v[148:151], v[212:215], v[24:27]
    v_mfma_f32_16x16x32_bf16 v[28:31], v[156:159], v[212:215], v[28:31]
    v_mfma_f32_16x16x32_bf16 v[28:31], v[152:155], v[208:211], v[28:31]
    s_waitcnt lgkmcnt(4)
    v_mfma_f32_16x16x32_bf16 v[44:47], v[152:155], v[216:219], v[44:47]
    ds_read_b128 v[208:211], v6 offset:2048
    v_mfma_f32_16x16x32_bf16 v[44:47], v[156:159], v[220:223], v[44:47]
    ds_read_b128 v[212:215], v6 offset:10240
    v_mfma_f32_16x16x32_bf16 v[40:43], v[148:151], v[220:223], v[40:43]
    v_mfma_f32_16x16x32_bf16 v[40:43], v[144:147], v[216:219], v[40:43]
    v_mfma_f32_16x16x32_bf16 v[36:39], v[136:139], v[216:219], v[36:39]
    v_mfma_f32_16x16x32_bf16 v[36:39], v[140:143], v[220:223], v[36:39]
    v_mfma_f32_16x16x32_bf16 v[32:35], v[132:135], v[220:223], v[32:35]
    v_mfma_f32_16x16x32_bf16 v[32:35], v[128:131], v[216:219], v[32:35]
    s_waitcnt lgkmcnt(4)
    v_mfma_f32_16x16x32_bf16 v[48:51], v[128:131], v[192:195], v[48:51]
    ds_read_b128 v[216:219], v6 offset:2560
    v_mfma_f32_16x16x32_bf16 v[48:51], v[132:135], v[196:199], v[48:51]
    ds_read_b128 v[220:223], v6 offset:10752
    v_mfma_f32_16x16x32_bf16 v[52:55], v[140:143], v[196:199], v[52:55]
    v_mfma_f32_16x16x32_bf16 v[52:55], v[136:139], v[192:195], v[52:55]
    v_mfma_f32_16x16x32_bf16 v[56:59], v[144:147], v[192:195], v[56:59]
    v_mfma_f32_16x16x32_bf16 v[56:59], v[148:151], v[196:199], v[56:59]
    v_mfma_f32_16x16x32_bf16 v[60:63], v[156:159], v[196:199], v[60:63]
    v_mfma_f32_16x16x32_bf16 v[60:63], v[152:155], v[192:195], v[60:63]
    s_waitcnt lgkmcnt(0)
    s_barrier
    v_mfma_f32_16x16x32_bf16 v[76:79], v[152:155], v[200:203], v[76:79]
    ds_read_b128 v[192:195], v6 offset:19456
    v_mfma_f32_16x16x32_bf16 v[76:79], v[156:159], v[204:207], v[76:79]
    ds_read_b128 v[196:199], v6 offset:27648
    v_mfma_f32_16x16x32_bf16 v[72:75], v[148:151], v[204:207], v[72:75]
    ds_read_b128 v[160:163], v2 offset:32768
    v_mfma_f32_16x16x32_bf16 v[72:75], v[144:147], v[200:203], v[72:75]
    ds_read_b128 v[164:167], v3 offset:32768
    v_mfma_f32_16x16x32_bf16 v[68:71], v[136:139], v[200:203], v[68:71]
    ds_read_b128 v[168:171], v2 offset:34816
    v_mfma_f32_16x16x32_bf16 v[68:71], v[140:143], v[204:207], v[68:71]
    ds_read_b128 v[172:175], v3 offset:34816
    v_mfma_f32_16x16x32_bf16 v[64:67], v[132:135], v[204:207], v[64:67]
    v_mfma_f32_16x16x32_bf16 v[64:67], v[128:131], v[200:203], v[64:67]
    v_mfma_f32_16x16x32_bf16 v[80:83], v[128:131], v[208:211], v[80:83]
    ds_read_b128 v[200:203], v6 offset:19968
    v_mfma_f32_16x16x32_bf16 v[80:83], v[132:135], v[212:215], v[80:83]
    ds_read_b128 v[204:207], v6 offset:28160
    v_mfma_f32_16x16x32_bf16 v[84:87], v[140:143], v[212:215], v[84:87]
    ds_read_b128 v[176:179], v2 offset:36864
    v_mfma_f32_16x16x32_bf16 v[84:87], v[136:139], v[208:211], v[84:87]
    ds_read_b128 v[180:183], v3 offset:36864
    v_mfma_f32_16x16x32_bf16 v[88:91], v[144:147], v[208:211], v[88:91]
    ds_read_b128 v[184:187], v2 offset:38912
    v_mfma_f32_16x16x32_bf16 v[88:91], v[148:151], v[212:215], v[88:91]
    ds_read_b128 v[188:191], v3 offset:38912
    v_mfma_f32_16x16x32_bf16 v[92:95], v[156:159], v[212:215], v[92:95]
    v_mfma_f32_16x16x32_bf16 v[92:95], v[152:155], v[208:211], v[92:95]
    v_mfma_f32_16x16x32_bf16 v[108:111], v[152:155], v[216:219], v[108:111]
    ds_read_b128 v[208:211], v6 offset:16384
    v_mfma_f32_16x16x32_bf16 v[108:111], v[156:159], v[220:223], v[108:111]
    ds_read_b128 v[212:215], v6 offset:24576
    v_mfma_f32_16x16x32_bf16 v[104:107], v[148:151], v[220:223], v[104:107]
    v_mfma_f32_16x16x32_bf16 v[104:107], v[144:147], v[216:219], v[104:107]
    v_mfma_f32_16x16x32_bf16 v[100:103], v[136:139], v[216:219], v[100:103]
    v_mfma_f32_16x16x32_bf16 v[100:103], v[140:143], v[220:223], v[100:103]
    v_mfma_f32_16x16x32_bf16 v[96:99], v[132:135], v[220:223], v[96:99]
    v_mfma_f32_16x16x32_bf16 v[96:99], v[128:131], v[216:219], v[96:99]
    s_waitcnt lgkmcnt(8)
    v_mfma_f32_16x16x32_bf16 v[112:115], v[160:163], v[192:195], v[112:115]
    ds_read_b128 v[216:219], v6 offset:16896
    v_mfma_f32_16x16x32_bf16 v[112:115], v[164:167], v[196:199], v[112:115]
    ds_read_b128 v[220:223], v6 offset:25088
    v_mfma_f32_16x16x32_bf16 v[116:119], v[172:175], v[196:199], v[116:119]
    v_mfma_f32_16x16x32_bf16 v[116:119], v[168:171], v[192:195], v[116:119]
    s_waitcnt lgkmcnt(8)
    v_mfma_f32_16x16x32_bf16 v[124:127], v[168:171], v[200:203], v[124:127]
    ds_read_b128 v[192:195], v6 offset:17408
    v_mfma_f32_16x16x32_bf16 v[124:127], v[172:175], v[204:207], v[124:127]
    ds_read_b128 v[196:199], v6 offset:25600
    v_mfma_f32_16x16x32_bf16 v[120:123], v[164:167], v[204:207], v[120:123]
    v_mfma_f32_16x16x32_bf16 v[120:123], v[160:163], v[200:203], v[120:123]
    s_waitcnt lgkmcnt(4)
    v_mfma_f32_16x16x32_bf16 v[16:19], v[160:163], v[208:211], v[16:19]
    ds_read_b128 v[200:203], v6 offset:17920
    v_mfma_f32_16x16x32_bf16 v[16:19], v[164:167], v[212:215], v[16:19]
    ds_read_b128 v[204:207], v6 offset:26112
    v_mfma_f32_16x16x32_bf16 v[20:23], v[172:175], v[212:215], v[20:23]
    v_mfma_f32_16x16x32_bf16 v[20:23], v[168:171], v[208:211], v[20:23]
    v_mfma_f32_16x16x32_bf16 v[24:27], v[176:179], v[208:211], v[24:27]
    v_mfma_f32_16x16x32_bf16 v[24:27], v[180:183], v[212:215], v[24:27]
    v_mfma_f32_16x16x32_bf16 v[28:31], v[188:191], v[212:215], v[28:31]
    v_mfma_f32_16x16x32_bf16 v[28:31], v[184:187], v[208:211], v[28:31]
    s_waitcnt lgkmcnt(4)
    v_mfma_f32_16x16x32_bf16 v[44:47], v[184:187], v[216:219], v[44:47]
    ds_read_b128 v[208:211], v6 offset:18432
    v_mfma_f32_16x16x32_bf16 v[44:47], v[188:191], v[220:223], v[44:47]
    ds_read_b128 v[212:215], v6 offset:26624
    v_mfma_f32_16x16x32_bf16 v[40:43], v[180:183], v[220:223], v[40:43]
    v_mfma_f32_16x16x32_bf16 v[40:43], v[176:179], v[216:219], v[40:43]
    v_mfma_f32_16x16x32_bf16 v[36:39], v[168:171], v[216:219], v[36:39]
    v_mfma_f32_16x16x32_bf16 v[36:39], v[172:175], v[220:223], v[36:39]
    v_mfma_f32_16x16x32_bf16 v[32:35], v[164:167], v[220:223], v[32:35]
    v_mfma_f32_16x16x32_bf16 v[32:35], v[160:163], v[216:219], v[32:35]
    s_waitcnt lgkmcnt(4)
    v_mfma_f32_16x16x32_bf16 v[48:51], v[160:163], v[192:195], v[48:51]
    ds_read_b128 v[216:219], v6 offset:18944
    v_mfma_f32_16x16x32_bf16 v[48:51], v[164:167], v[196:199], v[48:51]
    ds_read_b128 v[220:223], v6 offset:27136
    v_mfma_f32_16x16x32_bf16 v[52:55], v[172:175], v[196:199], v[52:55]
    v_mfma_f32_16x16x32_bf16 v[52:55], v[168:171], v[192:195], v[52:55]
    v_mfma_f32_16x16x32_bf16 v[56:59], v[176:179], v[192:195], v[56:59]
    v_mfma_f32_16x16x32_bf16 v[56:59], v[180:183], v[196:199], v[56:59]
    v_mfma_f32_16x16x32_bf16 v[60:63], v[188:191], v[196:199], v[60:63]
    v_mfma_f32_16x16x32_bf16 v[60:63], v[184:187], v[192:195], v[60:63]
    s_branch L_fin7
    .p2align 12
L_stub7:
    s_setpc_b64 s[74:75]
    s_nop 0
L_fin7:
    s_waitcnt lgkmcnt(0)
    s_barrier
    v_mfma_f32_16x16x32_bf16 v[76:79], v[184:187], v[200:203], v[76:79]
    ds_read_b128 v[192:195], v6 offset:35840
    v_mfma_f32_16x16x32_bf16 v[76:79], v[188:191], v[204:207], v[76:79]
    ds_read_b128 v[196:199], v6 offset:44032
    v_mfma_f32_16x16x32_bf16 v[72:75], v[180:183], v[204:207], v[72:75]
    ds_read_b128 v[128:131], v4 offset:0
    v_mfma_f32_16x16x32_bf16 v[72:75], v[176:179], v[200:203], v[72:75]
    ds_read_b128 v[132:135], v5 offset:0
    v_mfma_f32_16x16x32_bf16 v[68:71], v[168:171], v[200:203], v[68:71]
    ds_read_b128 v[136:139], v4 offset:2048
    v_mfma_f32_16x16x32_bf16 v[68:71], v[172:175], v[204:207], v[68:71]
    ds_read_b128 v[140:143], v5 offset:2048
    v_mfma_f32_16x16x32_bf16 v[64:67], v[164:167], v[204:207], v[64:67]
    v_mfma_f32_16x16x32_bf16 v[64:67], v[160:163], v[200:203], v[64:67]
    v_mfma_f32_16x16x32_bf16 v[80:83], v[160:163], v[208:211], v[80:83]
    ds_read_b128 v[200:203], v6 offset:36352
    v_mfma_f32_16x16x32_bf16 v[80:83], v[164:167], v[212:215], v[80:83]
    ds_read_b128 v[204:207], v6 offset:44544
    v_mfma_f32_16x16x32_bf16 v[84:87], v[172:175], v[212:215], v[84:87]
    ds_read_b128 v[144:147], v4 offset:4096
    v_mfma_f32_16x16x32_bf16 v[84:87], v[168:171], v[208:211], v[84:87]
    ds_read_b128 v[148:151], v5 offset:4096
    v_mfma_f32_16x16x32_bf16 v[88:91], v[176:179], v[208:211], v[88:91]
    ds_read_b128 v[152:155], v4 offset:6144
    v_mfma_f32_16x16x32_bf16 v[88:91], v[180:183], v[212:215], v[88:91]
    ds_read_b128 v[156:159], v5 offset:6144
    v_mfma_f32_16x16x32_bf16 v[92:95], v[188:191], v[212:215], v[92:95]
    v_mfma_f32_16x16x32_bf16 v[92:95], v[184:187], v[208:211], v[92:95]
    v_mfma_f32_16x16x32_bf16 v[108:111], v[184:187], v[216:219], v[108:111]
    ds_read_b128 v[208:211], v6 offset:32768
    v_mfma_f32_16x16x32_bf16 v[108:111], v[188:191], v[220:223], v[108:111]
    ds_read_b128 v[212:215], v6 offset:40960
    v_mfma_f32_16x16x32_bf16 v[104:107], v[180:183], v[220:223], v[104:107]
    v_mfma_f32_16x16x32_bf16 v[104:107], v[176:179], v[216:219], v[104:107]
    v_mfma_f32_16x16x32_bf16 v[100:103], v[168:171], v[216:219], v[100:103]
    v_mfma_f32_16x16x32_bf16 v[100:103], v[172:175], v[220:223], v[100:103]
    v_mfma_f32_16x16x32_bf16 v[96:99], v[164:167], v[220:223], v[96:99]
    v_mfma_f32_16x16x32_bf16 v[96:99], v[160:163], v[216:219], v[96:99]
    s_waitcnt lgkmcnt(8)
    v_mfma_f32_16x16x32_bf16 v[112:115], v[128:131], v[192:195], v[112:115]
    ds_read_b128 v[216:219], v6 offset:33280
    v_mfma_f32_16x16x32_bf16 v[112:115], v[132:135], v[196:199], v[112:115]
    ds_read_b128 v[220:223], v6 offset:41472
    v_mfma_f32_16x16x32_bf16 v[116:119], v[140:143], v[196:199], v[116:119]
    v_mfma_f32_16x16x32_bf16 v[116:119], v[136:139], v[192:195], v[116:119]
    s_waitcnt lgkmcnt(8)
    v_mfma_f32_16x16x32_bf16 v[124:127], v[136:139], v[200:203], v[124:127]
    ds_read_b128 v[192:195], v6 offset:33792
    v_mfma_f32_16x16x32_bf16 v[124:127], v[140:143], v[204:207], v[124:127]
    ds_read_b128 v[196:199], v6 offset:41984
    v_mfma_f32_16x16x32_bf16 v[120:123], v[132:135], v[204:207], v[120:123]
    v_mfma_f32_16x16x32_bf16 v[120:123], v[128:131], v[200:203], v[120:123]
    s_waitcnt lgkmcnt(4)
    v_mfma_f32_16x16x32_bf16 v[16:19], v[128:131], v[208:211], v[16:19]
    ds_read_b128 v[200:203], v6 offset:34304
    v_mfma_f32_16x16x32_bf16 v[16:19], v[132:135], v[212:215], v[16:19]
    ds_read_b128 v[204:207], v6 offset:42496
    v_mfma_f32_16x16x32_bf16 v[20:23], v[140:143], v[212:215], v[20:23]
    v_mfma_f32_16x16x32_bf16 v[20:23], v[136:139], v[208:211], v[20:23]
    v_mfma_f32_16x16x32_bf16 v[24:27], v[144:147], v[208:211], v[24:27]
    v_mfma_f32_16x16x32_bf16 v[24:27], v[148:151], v[212:215], v[24:27]
    v_mfma_f32_16x16x32_bf16 v[28:31], v[156:159], v[212:215], v[28:31]
    v_mfma_f32_16x16x32_bf16 v[28:31], v[152:155], v[208:211], v[28:31]
    s_waitcnt lgkmcnt(4)
    v_mfma_f32_16x16x32_bf16 v[44:47], v[152:155], v[216:219], v[44:47]
    ds_read_b128 v[208:211], v6 offset:34816
    v_mfma_f32_16x16x32_bf16 v[44:47], v[156:159], v[220:223], v[44:47]
    ds_read_b128 v[212:215], v6 offset:43008
    v_mfma_f32_16x16x32_bf16 v[40:43], v[148:151], v[220:223], v[40:43]
    v_mfma_f32_16x16x32_bf16 v[40:43], v[144:147], v[216:219], v[40:43]
    v_mfma_f32_16x16x32_bf16 v[36:39], v[136:139], v[216:219], v[36:39]
    v_mfma_f32_16x16x32_bf16 v[36:39], v[140:143], v[220:223], v[36:39]
    v_mfma_f32_16x16x32_bf16 v[32:35], v[132:135], v[220:223], v[32:35]
    v_mfma_f32_16x16x32_bf16 v[32:35], v[128:131], v[216:219], v[32:35]
    s_waitcnt lgkmcnt(4)
    v_mfma_f32_16x16x32_bf16 v[48:51], v[128:131], v[192:195], v[48:51]
    ds_read_b128 v[216:219], v6 offset:35328
    v_mfma_f32_16x16x32_bf16 v[48:51], v[132:135], v[196:199], v[48:51]
    ds_read_b128 v[220:223], v6 offset:43520
    v_mfma_f32_16x16x32_bf16 v[52:55], v[140:143], v[196:199], v[52:55]
    v_mfma_f32_16x16x32_bf16 v[52:55], v[136:139], v[192:195], v[52:55]
    v_mfma_f32_16x16x32_bf16 v[56:59], v[144:147], v[192:195], v[56:59]
    v_mfma_f32_16x16x32_bf16 v[56:59], v[148:151], v[196:199], v[56:59]
    v_mfma_f32_16x16x32_bf16 v[60:63], v[156:159], v[196:199], v[60:63]
    v_mfma_f32_16x16x32_bf16 v[60:63], v[152:155], v[192:195], v[60:63]
    s_waitcnt lgkmcnt(0)
    s_barrier
    v_mfma_f32_16x16x32_bf16 v[76:79], v[152:155], v[200:203], v[76:79]
    ds_read_b128 v[192:195], v6 offset:3072
    v_mfma_f32_16x16x32_bf16 v[76:79], v[156:159], v[204:207], v[76:79]
    ds_read_b128 v[196:199], v6 offset:11264
    v_mfma_f32_16x16x32_bf16 v[72:75], v[148:151], v[204:207], v[72:75]
    ds_read_b128 v[160:163], v2 offset:0
    v_mfma_f32_16x16x32_bf16 v[72:75], v[144:147], v[200:203], v[72:75]
    ds_read_b128 v[164:167], v3 offset:0
    v_mfma_f32_16x16x32_bf16 v[68:71], v[136:139], v[200:203], v[68:71]
    ds_read_b128 v[168:171], v2 offset:2048
    v_mfma_f32_16x16x32_bf16 v[68:71], v[140:143], v[204:207], v[68:71]
    ds_read_b128 v[172:175], v3 offset:2048
    v_mfma_f32_16x16x32_bf16 v[64:67], v[132:135], v[204:207], v[64:67]
    v_mfma_f32_16x16x32_bf16 v[64:67], v[128:131], v[200:203], v[64:67]
    v_mfma_f32_16x16x32_bf16 v[80:83], v[128:131], v[208:211], v[80:83]
    ds_read_b128 v[200:203], v6 offset:3584
    v_mfma_f32_16x16x32_bf16 v[80:83], v[132:135], v[212:215], v[80:83]
    ds_read_b128 v[204:207], v6 offset:11776
    v_mfma_f32_16x16x32_bf16 v[84:87], v[140:143], v[212:215], v[84:87]
    ds_read_b128 v[176:179], v2 offset:4096
    v_mfma_f32_16x16x32_bf16 v[84:87], v[136:139], v[208:211], v[84:87]
    ds_read_b128 v[180:183], v3 offset:4096
    v_mfma_f32_16x16x32_bf16 v[88:91], v[144:147], v[208:211], v[88:91]
    ds_read_b128 v[184:187], v2 offset:6144
    v_mfma_f32_16x16x32_bf16 v[88:91], v[148:151], v[212:215], v[88:91]
    ds_read_b128 v[188:191], v3 offset:6144
    v_mfma_f32_16x16x32_bf16 v[92:95], v[156:159], v[212:215], v[92:95]
    v_mfma_f32_16x16x32_bf16 v[92:95], v[152:155], v[208:211], v[92:95]
    v_mfma_f32_16x16x32_bf16 v[108:111], v[152:155], v[216:219], v[108:111]
    ds_read_b128 v[208:211], v6 offset:0
    v_mfma_f32_16x16x32_bf16 v[108:111], v[156:159], v[220:223], v[108:111]
    ds_read_b128 v[212:215], v6 offset:8192
    v_mfma_f32_16x16x32_bf16 v[104:107], v[148:151], v[220:223], v[104:107]
    v_mfma_f32_16x16x32_bf16 v[104:107], v[144:147], v[216:219], v[104:107]
    v_mfma_f32_16x16x32_bf16 v[100:103], v[136:139], v[216:219], v[100:103]
    v_mfma_f32_16x16x32_bf16 v[100:103], v[140:143], v[220:223], v[100:103]
    v_mfma_f32_16x16x32_bf16 v[96:99], v[132:135], v[220:223], v[96:99]
    v_mfma_f32_16x16x32_bf16 v[96:99], v[128:131], v[216:219], v[96:99]
    s_waitcnt lgkmcnt(8)
    v_mfma_f32_16x16x32_bf16 v[112:115], v[160:163], v[192:195], v[112:115]
    ds_read_b128 v[216:219], v6 offset:512
    v_mfma_f32_16x16x32_bf16 v[112:115], v[164:167], v[196:199], v[112:115]
    ds_read_b128 v[220:223], v6 offset:8704
    v_mfma_f32_16x16x32_bf16 v[116:119], v[172:175], v[196:199], v[116:119]
    v_mfma_f32_16x16x32_bf16 v[116:119], v[168:171], v[192:195], v[116:119]
    s_waitcnt lgkmcnt(8)
    v_mfma_f32_16x16x32_bf16 v[124:127], v[168:171], v[200:203], v[124:127]
    ds_read_b128 v[192:195], v6 offset:1024
    v_mfma_f32_16x16x32_bf16 v[124:127], v[172:175], v[204:207], v[124:127]
    ds_read_b128 v[196:199], v6 offset:9216
    v_mfma_f32_16x16x32_bf16 v[120:123], v[164:167], v[204:207], v[120:123]
    v_mfma_f32_16x16x32_bf16 v[120:123], v[160:163], v[200:203], v[120:123]
    s_waitcnt lgkmcnt(4)
    v_mfma_f32_16x16x32_bf16 v[16:19], v[160:163], v[208:211], v[16:19]
    ds_read_b128 v[200:203], v6 offset:1536
    v_mfma_f32_16x16x32_bf16 v[16:19], v[164:167], v[212:215], v[16:19]
    ds_read_b128 v[204:207], v6 offset:9728
    v_mfma_f32_16x16x32_bf16 v[20:23], v[172:175], v[212:215], v[20:23]
    v_mfma_f32_16x16x32_bf16 v[20:23], v[168:171], v[208:211], v[20:23]
    v_mfma_f32_16x16x32_bf16 v[24:27], v[176:179], v[208:211], v[24:27]
    v_mfma_f32_16x16x32_bf16 v[24:27], v[180:183], v[212:215], v[24:27]
    v_mfma_f32_16x16x32_bf16 v[28:31], v[188:191], v[212:215], v[28:31]
    v_mfma_f32_16x16x32_bf16 v[28:31], v[184:187], v[208:211], v[28:31]
    s_waitcnt lgkmcnt(4)
    v_mfma_f32_16x16x32_bf16 v[44:47], v[184:187], v[216:219], v[44:47]
    ds_read_b128 v[208:211], v6 offset:2048
    v_mfma_f32_16x16x32_bf16 v[44:47], v[188:191], v[220:223], v[44:47]
    ds_read_b128 v[212:215], v6 offset:10240
    v_mfma_f32_16x16x32_bf16 v[40:43], v[180:183], v[220:223], v[40:43]
    v_mfma_f32_16x16x32_bf16 v[40:43], v[176:179], v[216:219], v[40:43]
    v_mfma_f32_16x16x32_bf16 v[36:39], v[168:171], v[216:219], v[36:39]
    v_mfma_f32_16x16x32_bf16 v[36:39], v[172:175], v[220:223], v[36:39]
    v_mfma_f32_16x16x32_bf16 v[32:35], v[164:167], v[220:223], v[32:35]
    v_mfma_f32_16x16x32_bf16 v[32:35], v[160:163], v[216:219], v[32:35]
    s_waitcnt lgkmcnt(4)
    v_mfma_f32_16x16x32_bf16 v[48:51], v[160:163], v[192:195], v[48:51]
    ds_read_b128 v[216:219], v6 offset:2560
    v_mfma_f32_16x16x32_bf16 v[48:51], v[164:167], v[196:199], v[48:51]
    ds_read_b128 v[220:223], v6 offset:10752
    v_mfma_f32_16x16x32_bf16 v[52:55], v[172:175], v[196:199], v[52:55]
    v_mfma_f32_16x16x32_bf16 v[52:55], v[168:171], v[192:195], v[52:55]
    v_mfma_f32_16x16x32_bf16 v[56:59], v[176:179], v[192:195], v[56:59]
    v_mfma_f32_16x16x32_bf16 v[56:59], v[180:183], v[196:199], v[56:59]
    v_mfma_f32_16x16x32_bf16 v[60:63], v[188:191], v[196:199], v[60:63]
    v_mfma_f32_16x16x32_bf16 v[60:63], v[184:187], v[192:195], v[60:63]
    s_waitcnt lgkmcnt(0)
    s_barrier
    v_mfma_f32_16x16x32_bf16 v[76:79], v[184:187], v[200:203], v[76:79]
    ds_read_b128 v[192:195], v6 offset:19456
    v_mfma_f32_16x16x32_bf16 v[76:79], v[188:191], v[204:207], v[76:79]
    ds_read_b128 v[196:199], v6 offset:27648
    v_mfma_f32_16x16x32_bf16 v[72:75], v[180:183], v[204:207], v[72:75]
    ds_read_b128 v[128:131], v2 offset:32768
    v_mfma_f32_16x16x32_bf16 v[72:75], v[176:179], v[200:203], v[72:75]
    ds_read_b128 v[132:135], v3 offset:32768
    v_mfma_f32_16x16x32_bf16 v[68:71], v[168:171], v[200:203], v[68:71]
    ds_read_b128 v[136:139], v2 offset:34816
    v_mfma_f32_16x16x32_bf16 v[68:71], v[172:175], v[204:207], v[68:71]
    ds_read_b128 v[140:143], v3 offset:34816
    v_mfma_f32_16x16x32_bf16 v[64:67], v[164:167], v[204:207], v[64:67]
    v_mfma_f32_16x16x32_bf16 v[64:67], v[160:163], v[200:203], v[64:67]
    v_mfma_f32_16x16x32_bf16 v[80:83], v[160:163], v[208:211], v[80:83]
    ds_read_b128 v[200:203], v6 offset:19968
    v_mfma_f32_16x16x32_bf16 v[80:83], v[164:167], v[212:215], v[80:83]
    ds_read_b128 v[204:207], v6 offset:28160
    v_mfma_f32_16x16x32_bf16 v[84:87], v[172:175], v[212:215], v[84:87]
    ds_read_b128 v[144:147], v2 offset:36864
    v_mfma_f32_16x16x32_bf16 v[84:87], v[168:171], v[208:211], v[84:87]
    ds_read_b128 v[148:151], v3 offset:36864
    v_mfma_f32_16x16x32_bf16 v[88:91], v[176:179], v[208:211], v[88:91]
    ds_read_b128 v[152:155], v2 offset:38912
    v_mfma_f32_16x16x32_bf16 v[88:91], v[180:183], v[212:215], v[88:91]
    ds_read_b128 v[156:159], v3 offset:38912
    v_mfma_f32_16x16x32_bf16 v[92:95], v[188:191], v[212:215], v[92:95]
    v_mfma_f32_16x16x32_bf16 v[92:95], v[184:187], v[208:211], v[92:95]
    v_mfma_f32_16x16x32_bf16 v[108:111], v[184:187], v[216:219], v[108:111]
    ds_read_b128 v[208:211], v6 offset:16384
    v_mfma_f32_16x16x32_bf16 v[108:111], v[188:191], v[220:223], v[108:111]
    ds_read_b128 v[212:215], v6 offset:24576
    v_mfma_f32_16x16x32_bf16 v[104:107], v[180:183], v[220:223], v[104:107]
    v_mfma_f32_16x16x32_bf16 v[104:107], v[176:179], v[216:219], v[104:107]
    v_mfma_f32_16x16x32_bf16 v[100:103], v[168:171], v[216:219], v[100:103]
    v_mfma_f32_16x16x32_bf16 v[100:103], v[172:175], v[220:223], v[100:103]
    v_mfma_f32_16x16x32_bf16 v[96:99], v[164:167], v[220:223], v[96:99]
    v_mfma_f32_16x16x32_bf16 v[96:99], v[160:163], v[216:219], v[96:99]
    s_waitcnt lgkmcnt(8)
    v_mfma_f32_16x16x32_bf16 v[112:115], v[128:131], v[192:195], v[112:115]
    ds_read_b128 v[216:219], v6 offset:16896
    v_mfma_f32_16x16x32_bf16 v[112:115], v[132:135], v[196:199], v[112:115]
    ds_read_b128 v[220:223], v6 offset:25088
    v_mfma_f32_16x16x32_bf16 v[116:119], v[140:143], v[196:199], v[116:119]
    v_mfma_f32_16x16x32_bf16 v[116:119], v[136:139], v[192:195], v[116:119]
    s_waitcnt lgkmcnt(8)
    v_mfma_f32_16x16x32_bf16 v[124:127], v[136:139], v[200:203], v[124:127]
    ds_read_b128 v[192:195], v6 offset:17408
    v_mfma_f32_16x16x32_bf16 v[124:127], v[140:143], v[204:207], v[124:127]
    ds_read_b128 v[196:199], v6 offset:25600
    v_mfma_f32_16x16x32_bf16 v[120:123], v[132:135], v[204:207], v[120:123]
    v_mfma_f32_16x16x32_bf16 v[120:123], v[128:131], v[200:203], v[120:123]
    s_waitcnt lgkmcnt(4)
    v_mfma_f32_16x16x32_bf16 v[16:19], v[128:131], v[208:211], v[16:19]
    ds_read_b128 v[200:203], v6 offset:17920
    v_mfma_f32_16x16x32_bf16 v[16:19], v[132:135], v[212:215], v[16:19]
    ds_read_b128 v[204:207], v6 offset:26112
    v_mfma_f32_16x16x32_bf16 v[20:23], v[140:143], v[212:215], v[20:23]
    v_mfma_f32_16x16x32_bf16 v[20:23], v[136:139], v[208:211], v[20:23]
    v_mfma_f32_16x16x32_bf16 v[24:27], v[144:147], v[208:211], v[24:27]
    v_mfma_f32_16x16x32_bf16 v[24:27], v[148:151], v[212:215], v[24:27]
    v_mfma_f32_16x16x32_bf16 v[28:31], v[156:159], v[212:215], v[28:31]
    v_mfma_f32_16x16x32_bf16 v[28:31], v[152:155], v[208:211], v[28:31]
    s_waitcnt lgkmcnt(4)
    v_mfma_f32_16x16x32_bf16 v[44:47], v[152:155], v[216:219], v[44:47]
    ds_read_b128 v[208:211], v6 offset:18432
    v_mfma_f32_16x16x32_bf16 v[44:47], v[156:159], v[220:223], v[44:47]
    ds_read_b128 v[212:215], v6 offset:26624
    v_mfma_f32_16x16x32_bf16 v[40:43], v[148:151], v[220:223], v[40:43]
    v_mfma_f32_16x16x32_bf16 v[40:43], v[144:147], v[216:219], v[40:43]
    v_mfma_f32_16x16x32_bf16 v[36:39], v[136:139], v[216:219], v[36:39]
    v_mfma_f32_16x16x32_bf16 v[36:39], v[140:143], v[220:223], v[36:39]
    v_mfma_f32_16x16x32_bf16 v[32:35], v[132:135], v[220:223], v[32:35]
    v_mfma_f32_16x16x32_bf16 v[32:35], v[128:131], v[216:219], v[32:35]
    s_waitcnt lgkmcnt(4)
    v_mfma_f32_16x16x32_bf16 v[48:51], v[128:131], v[192:195], v[48:51]
    ds_read_b128 v[216:219], v6 offset:18944
    v_mfma_f32_16x16x32_bf16 v[48:51], v[132:135], v[196:199], v[48:51]
    ds_read_b128 v[220:223], v6 offset:27136
    v_mfma_f32_16x16x32_bf16 v[52:55], v[140:143], v[196:199], v[52:55]
    v_mfma_f32_16x16x32_bf16 v[52:55], v[136:139], v[192:195], v[52:55]
    v_mfma_f32_16x16x32_bf16 v[56:59], v[144:147], v[192:195], v[56:59]
    v_mfma_f32_16x16x32_bf16 v[56:59], v[148:151], v[196:199], v[56:59]
    v_mfma_f32_16x16x32_bf16 v[60:63], v[156:159], v[196:199], v[60:63]
    v_mfma_f32_16x16x32_bf16 v[60:63], v[152:155], v[192:195], v[60:63]
    s_waitcnt lgkmcnt(0)
    s_barrier
    v_mfma_f32_16x16x32_bf16 v[76:79], v[152:155], v[200:203], v[76:79]
    ds_read_b128 v[192:195], v6 offset:35840
    v_mfma_f32_16x16x32_bf16 v[76:79], v[156:159], v[204:207], v[76:79]
    ds_read_b128 v[196:199], v6 offset:44032
    v_mfma_f32_16x16x32_bf16 v[72:75], v[148:151], v[204:207], v[72:75]
    ds_read_b128 v[160:163], v4 offset:0
    v_mfma_f32_16x16x32_bf16 v[72:75], v[144:147], v[200:203], v[72:75]
    ds_read_b128 v[164:167], v5 offset:0
    v_mfma_f32_16x16x32_bf16 v[68:71], v[136:139], v[200:203], v[68:71]
    ds_read_b128 v[168:171], v4 offset:2048
    v_mfma_f32_16x16x32_bf16 v[68:71], v[140:143], v[204:207], v[68:71]
    ds_read_b128 v[172:175], v5 offset:2048
    v_mfma_f32_16x16x32_bf16 v[64:67], v[132:135], v[204:207], v[64:67]
    v_mfma_f32_16x16x32_bf16 v[64:67], v[128:131], v[200:203], v[64:67]
    v_mfma_f32_16x16x32_bf16 v[80:83], v[128:131], v[208:211], v[80:83]
    ds_read_b128 v[200:203], v6 offset:36352
    v_mfma_f32_16x16x32_bf16 v[80:83], v[132:135], v[212:215], v[80:83]
    ds_read_b128 v[204:207], v6 offset:44544
    v_mfma_f32_16x16x32_bf16 v[84:87], v[140:143], v[212:215], v[84:87]
    ds_read_b128 v[176:179], v4 offset:4096
    v_mfma_f32_16x16x32_bf16 v[84:87], v[136:139], v[208:211], v[84:87]
    ds_read_b128 v[180:183], v5 offset:4096
    v_mfma_f32_16x16x32_bf16 v[88:91], v[144:147], v[208:211], v[88:91]
    ds_read_b128 v[184:187], v4 offset:6144
    v_mfma_f32_16x16x32_bf16 v[88:91], v[148:151], v[212:215], v[88:91]
    ds_read_b128 v[188:191], v5 offset:6144
    v_mfma_f32_16x16x32_bf16 v[92:95], v[156:159], v[212:215], v[92:95]
    v_mfma_f32_16x16x32_bf16 v[92:95], v[152:155], v[208:211], v[92:95]
    v_mfma_f32_16x16x32_bf16 v[108:111], v[152:155], v[216:219], v[108:111]
    ds_read_b128 v[208:211], v6 offset:32768
    v_mfma_f32_16x16x32_bf16 v[108:111], v[156:159], v[220:223], v[108:111]
    ds_read_b128 v[212:215], v6 offset:40960
    v_mfma_f32_16x16x32_bf16 v[104:107], v[148:151], v[220:223], v[104:107]
    v_mfma_f32_16x16x32_bf16 v[104:107], v[144:147], v[216:219], v[104:107]
    v_mfma_f32_16x16x32_bf16 v[100:103], v[136:139], v[216:219], v[100:103]
    v_mfma_f32_16x16x32_bf16 v[100:103], v[140:143], v[220:223], v[100:103]
    v_mfma_f32_16x16x32_bf16 v[96:99], v[132:135], v[220:223], v[96:99]
    v_mfma_f32_16x16x32_bf16 v[96:99], v[128:131], v[216:219], v[96:99]
    s_waitcnt lgkmcnt(8)
    v_mfma_f32_16x16x32_bf16 v[112:115], v[160:163], v[192:195], v[112:115]
    ds_read_b128 v[216:219], v6 offset:33280
    v_mfma_f32_16x16x32_bf16 v[112:115], v[164:167], v[196:199], v[112:115]
    ds_read_b128 v[220:223], v6 offset:41472
    v_mfma_f32_16x16x32_bf16 v[116:119], v[172:175], v[196:199], v[116:119]
    v_mfma_f32_16x16x32_bf16 v[116:119], v[168:171], v[192:195], v[116:119]
    s_waitcnt lgkmcnt(8)
    v_mfma_f32_16x16x32_bf16 v[124:127], v[168:171], v[200:203], v[124:127]
    ds_read_b128 v[192:195], v6 offset:33792
    v_mfma_f32_16x16x32_bf16 v[124:127], v[172:175], v[204:207], v[124:127]
    ds_read_b128 v[196:199], v6 offset:41984
    v_mfma_f32_16x16x32_bf16 v[120:123], v[164:167], v[204:207], v[120:123]
    v_mfma_f32_16x16x32_bf16 v[120:123], v[160:163], v[200:203], v[120:123]
    s_waitcnt lgkmcnt(4)
    v_mfma_f32_16x16x32_bf16 v[16:19], v[160:163], v[208:211], v[16:19]
    ds_read_b128 v[200:203], v6 offset:34304
    v_mfma_f32_16x16x32_bf16 v[16:19], v[164:167], v[212:215], v[16:19]
    ds_read_b128 v[204:207], v6 offset:42496
    v_mfma_f32_16x16x32_bf16 v[20:23], v[172:175], v[212:215], v[20:23]
    v_mfma_f32_16x16x32_bf16 v[20:23], v[168:171], v[208:211], v[20:23]
    v_mfma_f32_16x16x32_bf16 v[24:27], v[176:179], v[208:211], v[24:27]
    v_mfma_f32_16x16x32_bf16 v[24:27], v[180:183], v[212:215], v[24:27]
    v_mfma_f32_16x16x32_bf16 v[28:31], v[188:191], v[212:215], v[28:31]
    v_mfma_f32_16x16x32_bf16 v[28:31], v[184:187], v[208:211], v[28:31]
    s_waitcnt lgkmcnt(4)
    v_mfma_f32_16x16x32_bf16 v[44:47], v[184:187], v[216:219], v[44:47]
    ds_read_b128 v[208:211], v6 offset:34816
    v_mfma_f32_16x16x32_bf16 v[44:47], v[188:191], v[220:223], v[44:47]
    ds_read_b128 v[212:215], v6 offset:43008
    v_mfma_f32_16x16x32_bf16 v[40:43], v[180:183], v[220:223], v[40:43]
    v_mfma_f32_16x16x32_bf16 v[40:43], v[176:179], v[216:219], v[40:43]
    v_mfma_f32_16x16x32_bf16 v[36:39], v[168:171], v[216:219], v[36:39]
    v_mfma_f32_16x16x32_bf16 v[36:39], v[172:175], v[220:223], v[36:39]
    v_mfma_f32_16x16x32_bf16 v[32:35], v[164:167], v[220:223], v[32:35]
    v_mfma_f32_16x16x32_bf16 v[32:35], v[160:163], v[216:219], v[32:35]
    s_waitcnt lgkmcnt(4)
    v_mfma_f32_16x16x32_bf16 v[48:51], v[160:163], v[192:195], v[48:51]
    ds_read_b128 v[216:219], v6 offset:35328
    v_mfma_f32_16x16x32_bf16 v[48:51], v[164:167], v[196:199], v[48:51]
    ds_read_b128 v[220:223], v6 offset:43520
    v_mfma_f32_16x16x32_bf16 v[52:55], v[172:175], v[196:199], v[52:55]
    v_mfma_f32_16x16x32_bf16 v[52:55], v[168:171], v[192:195], v[52:55]
    v_mfma_f32_16x16x32_bf16 v[56:59], v[176:179], v[192:195], v[56:59]
    v_mfma_f32_16x16x32_bf16 v[56:59], v[180:183], v[196:199], v[56:59]
    v_mfma_f32_16x16x32_bf16 v[60:63], v[188:191], v[196:199], v[60:63]
    v_mfma_f32_16x16x32_bf16 v[60:63], v[184:187], v[192:195], v[60:63]
    s_waitcnt vmcnt(0)
    s_waitcnt lgkmcnt(0)
    s_barrier
    v_mfma_f32_16x16x32_bf16 v[76:79], v[184:187], v[200:203], v[76:79]
    ds_read_b128 v[192:195], v6 offset:3072
    v_mfma_f32_16x16x32_bf16 v[76:79], v[188:191], v[204:207], v[76:79]
    ds_read_b128 v[196:199], v6 offset:11264
    v_mfma_f32_16x16x32_bf16 v[72:75], v[180:183], v[204:207], v[72:75]
    ds_read_b128 v[128:131], v2 offset:0
    v_mfma_f32_16x16x32_bf16 v[72:75], v[176:179], v[200:203], v[72:75]
    ds_read_b128 v[132:135], v3 offset:0
    v_mfma_f32_16x16x32_bf16 v[68:71], v[168:171], v[200:203], v[68:71]
    ds_read_b128 v[136:139], v2 offset:2048
    v_mfma_f32_16x16x32_bf16 v[68:71], v[172:175], v[204:207], v[68:71]
    ds_read_b128 v[140:143], v3 offset:2048
    v_mfma_f32_16x16x32_bf16 v[64:67], v[164:167], v[204:207], v[64:67]
    v_mfma_f32_16x16x32_bf16 v[64:67], v[160:163], v[200:203], v[64:67]
    v_mfma_f32_16x16x32_bf16 v[80:83], v[160:163], v[208:211], v[80:83]
    ds_read_b128 v[200:203], v6 offset:3584
    v_mfma_f32_16x16x32_bf16 v[80:83], v[164:167], v[212:215], v[80:83]
    ds_read_b128 v[204:207], v6 offset:11776
    v_mfma_f32_16x16x32_bf16 v[84:87], v[172:175], v[212:215], v[84:87]
    ds_read_b128 v[144:147], v2 offset:4096
    v_mfma_f32_16x16x32_bf16 v[84:87], v[168:171], v[208:211], v[84:87]
    ds_read_b128 v[148:151], v3 offset:4096
    v_mfma_f32_16x16x32_bf16 v[88:91], v[176:179], v[208:211], v[88:91]
    ds_read_b128 v[152:155], v2 offset:6144
    v_mfma_f32_16x16x32_bf16 v[88:91], v[180:183], v[212:215], v[88:91]
    ds_read_b128 v[156:159], v3 offset:6144
    v_mfma_f32_16x16x32_bf16 v[92:95], v[188:191], v[212:215], v[92:95]
    v_mfma_f32_16x16x32_bf16 v[92:95], v[184:187], v[208:211], v[92:95]
    v_mfma_f32_16x16x32_bf16 v[108:111], v[184:187], v[216:219], v[108:111]
    ds_read_b128 v[208:211], v6 offset:0
    v_mfma_f32_16x16x32_bf16 v[108:111], v[188:191], v[220:223], v[108:111]
    ds_read_b128 v[212:215], v6 offset:8192
    v_mfma_f32_16x16x32_bf16 v[104:107], v[180:183], v[220:223], v[104:107]
    v_mfma_f32_16x16x32_bf16 v[104:107], v[176:179], v[216:219], v[104:107]
    v_mfma_f32_16x16x32_bf16 v[100:103], v[168:171], v[216:219], v[100:103]
    v_mfma_f32_16x16x32_bf16 v[100:103], v[172:175], v[220:223], v[100:103]
    v_mfma_f32_16x16x32_bf16 v[96:99], v[164:167], v[220:223], v[96:99]
    v_mfma_f32_16x16x32_bf16 v[96:99], v[160:163], v[216:219], v[96:99]
    s_waitcnt lgkmcnt(8)
    v_mfma_f32_16x16x32_bf16 v[112:115], v[128:131], v[192:195], v[112:115]
    ds_read_b128 v[216:219], v6 offset:512
    v_mfma_f32_16x16x32_bf16 v[112:115], v[132:135], v[196:199], v[112:115]
    ds_read_b128 v[220:223], v6 offset:8704
    v_mfma_f32_16x16x32_bf16 v[116:119], v[140:143], v[196:199], v[116:119]
    v_mfma_f32_16x16x32_bf16 v[116:119], v[136:139], v[192:195], v[116:119]
    s_waitcnt lgkmcnt(8)
    v_mfma_f32_16x16x32_bf16 v[124:127], v[136:139], v[200:203], v[124:127]
    ds_read_b128 v[192:195], v6 offset:1024
    v_mfma_f32_16x16x32_bf16 v[124:127], v[140:143], v[204:207], v[124:127]
    ds_read_b128 v[196:199], v6 offset:9216
    v_mfma_f32_16x16x32_bf16 v[120:123], v[132:135], v[204:207], v[120:123]
    v_mfma_f32_16x16x32_bf16 v[120:123], v[128:131], v[200:203], v[120:123]
    s_waitcnt lgkmcnt(4)
    v_mfma_f32_16x16x32_bf16 v[16:19], v[128:131], v[208:211], v[16:19]
    ds_read_b128 v[200:203], v6 offset:1536
    v_mfma_f32_16x16x32_bf16 v[16:19], v[132:135], v[212:215], v[16:19]
    ds_read_b128 v[204:207], v6 offset:9728
    v_mfma_f32_16x16x32_bf16 v[20:23], v[140:143], v[212:215], v[20:23]
    v_mfma_f32_16x16x32_bf16 v[20:23], v[136:139], v[208:211], v[20:23]
    v_mfma_f32_16x16x32_bf16 v[24:27], v[144:147], v[208:211], v[24:27]
    v_mfma_f32_16x16x32_bf16 v[24:27], v[148:151], v[212:215], v[24:27]
    v_mfma_f32_16x16x32_bf16 v[28:31], v[156:159], v[212:215], v[28:31]
    v_mfma_f32_16x16x32_bf16 v[28:31], v[152:155], v[208:211], v[28:31]
    s_waitcnt lgkmcnt(4)
    v_mfma_f32_16x16x32_bf16 v[44:47], v[152:155], v[216:219], v[44:47]
    ds_read_b128 v[208:211], v6 offset:2048
    v_mfma_f32_16x16x32_bf16 v[44:47], v[156:159], v[220:223], v[44:47]
    ds_read_b128 v[212:215], v6 offset:10240
    v_mfma_f32_16x16x32_bf16 v[40:43], v[148:151], v[220:223], v[40:43]
    v_mfma_f32_16x16x32_bf16 v[40:43], v[144:147], v[216:219], v[40:43]
    v_mfma_f32_16x16x32_bf16 v[36:39], v[136:139], v[216:219], v[36:39]
    v_mfma_f32_16x16x32_bf16 v[36:39], v[140:143], v[220:223], v[36:39]
    v_mfma_f32_16x16x32_bf16 v[32:35], v[132:135], v[220:223], v[32:35]
    v_mfma_f32_16x16x32_bf16 v[32:35], v[128:131], v[216:219], v[32:35]
    s_waitcnt lgkmcnt(4)
    v_mfma_f32_16x16x32_bf16 v[48:51], v[128:131], v[192:195], v[48:51]
    ds_read_b128 v[216:219], v6 offset:2560
    v_mfma_f32_16x16x32_bf16 v[48:51], v[132:135], v[196:199], v[48:51]
    ds_read_b128 v[220:223], v6 offset:10752
    v_mfma_f32_16x16x32_bf16 v[52:55], v[140:143], v[196:199], v[52:55]
    v_mfma_f32_16x16x32_bf16 v[52:55], v[136:139], v[192:195], v[52:55]
    v_mfma_f32_16x16x32_bf16 v[56:59], v[144:147], v[192:195], v[56:59]
    v_mfma_f32_16x16x32_bf16 v[56:59], v[148:151], v[196:199], v[56:59]
    v_mfma_f32_16x16x32_bf16 v[60:63], v[156:159], v[196:199], v[60:63]
    v_mfma_f32_16x16x32_bf16 v[60:63], v[152:155], v[192:195], v[60:63]
    s_waitcnt lgkmcnt(0)
    s_barrier
    v_mfma_f32_16x16x32_bf16 v[76:79], v[152:155], v[200:203], v[76:79]
    ds_read_b128 v[192:195], v6 offset:19456
    v_mfma_f32_16x16x32_bf16 v[76:79], v[156:159], v[204:207], v[76:79]
    ds_read_b128 v[196:199], v6 offset:27648
    v_mfma_f32_16x16x32_bf16 v[72:75], v[148:151], v[204:207], v[72:75]
    ds_read_b128 v[160:163], v2 offset:32768
    v_mfma_f32_16x16x32_bf16 v[72:75], v[144:147], v[200:203], v[72:75]
    ds_read_b128 v[164:167], v3 offset:32768
    v_mfma_f32_16x16x32_bf16 v[68:71], v[136:139], v[200:203], v[68:71]
    ds_read_b128 v[168:171], v2 offset:34816
    v_mfma_f32_16x16x32_bf16 v[68:71], v[140:143], v[204:207], v[68:71]
    ds_read_b128 v[172:175], v3 offset:34816
    v_mfma_f32_16x16x32_bf16 v[64:67], v[132:135], v[204:207], v[64:67]
    v_mfma_f32_16x16x32_bf16 v[64:67], v[128:131], v[200:203], v[64:67]
    v_mfma_f32_16x16x32_bf16 v[80:83], v[128:131], v[208:211], v[80:83]
    ds_read_b128 v[200:203], v6 offset:19968
    v_mfma_f32_16x16x32_bf16 v[80:83], v[132:135], v[212:215], v[80:83]
    ds_read_b128 v[204:207], v6 offset:28160
    v_mfma_f32_16x16x32_bf16 v[84:87], v[140:143], v[212:215], v[84:87]
    ds_read_b128 v[176:179], v2 offset:36864
    v_mfma_f32_16x16x32_bf16 v[84:87], v[136:139], v[208:211], v[84:87]
    ds_read_b128 v[180:183], v3 offset:36864
    v_mfma_f32_16x16x32_bf16 v[88:91], v[144:147], v[208:211], v[88:91]
    ds_read_b128 v[184:187], v2 offset:38912
    v_mfma_f32_16x16x32_bf16 v[88:91], v[148:151], v[212:215], v[88:91]
    ds_read_b128 v[188:191], v3 offset:38912
    v_mfma_f32_16x16x32_bf16 v[92:95], v[156:159], v[212:215], v[92:95]
    v_mfma_f32_16x16x32_bf16 v[92:95], v[152:155], v[208:211], v[92:95]
    v_mfma_f32_16x16x32_bf16 v[108:111], v[152:155], v[216:219], v[108:111]
    ds_read_b128 v[208:211], v6 offset:18432
    v_mfma_f32_16x16x32_bf16 v[108:111], v[156:159], v[220:223], v[108:111]
    ds_read_b128 v[212:215], v6 offset:26624
    v_mfma_f32_16x16x32_bf16 v[104:107], v[148:151], v[220:223], v[104:107]
    v_mfma_f32_16x16x32_bf16 v[104:107], v[144:147], v[216:219], v[104:107]
    v_mfma_f32_16x16x32_bf16 v[100:103], v[136:139], v[216:219], v[100:103]
    v_mfma_f32_16x16x32_bf16 v[100:103], v[140:143], v[220:223], v[100:103]
    v_mfma_f32_16x16x32_bf16 v[96:99], v[132:135], v[220:223], v[96:99]
    v_mfma_f32_16x16x32_bf16 v[96:99], v[128:131], v[216:219], v[96:99]
    s_waitcnt lgkmcnt(8)
    v_mfma_f32_16x16x32_bf16 v[112:115], v[160:163], v[192:195], v[112:115]
    ds_read_b128 v[216:219], v6 offset:18944
    v_mfma_f32_16x16x32_bf16 v[112:115], v[164:167], v[196:199], v[112:115]
    ds_read_b128 v[220:223], v6 offset:27136
    v_mfma_f32_16x16x32_bf16 v[116:119], v[172:175], v[196:199], v[116:119]
    v_mfma_f32_16x16x32_bf16 v[116:119], v[168:171], v[192:195], v[116:119]
    s_waitcnt lgkmcnt(8)
    v_mfma_f32_16x16x32_bf16 v[124:127], v[168:171], v[200:203], v[124:127]
    v_mfma_f32_16x16x32_bf16 v[124:127], v[172:175], v[204:207], v[124:127]
    v_mfma_f32_16x16x32_bf16 v[120:123], v[164:167], v[204:207], v[120:123]
    v_mfma_f32_16x16x32_bf16 v[120:123], v[160:163], v[200:203], v[120:123]
    s_waitcnt lgkmcnt(2)
    v_mfma_f32_16x16x32_bf16 v[80:83], v[160:163], v[208:211], v[80:83]
    v_mfma_f32_16x16x32_bf16 v[80:83], v[164:167], v[212:215], v[80:83]
    v_mfma_f32_16x16x32_bf16 v[84:87], v[172:175], v[212:215], v[84:87]
    v_mfma_f32_16x16x32_bf16 v[84:87], v[168:171], v[208:211], v[84:87]
    v_mfma_f32_16x16x32_bf16 v[88:91], v[176:179], v[208:211], v[88:91]
    v_mfma_f32_16x16x32_bf16 v[88:91], v[180:183], v[212:215], v[88:91]
    v_mfma_f32_16x16x32_bf16 v[92:95], v[188:191], v[212:215], v[92:95]
    v_mfma_f32_16x16x32_bf16 v[92:95], v[184:187], v[208:211], v[92:95]
    s_branch L_fin13
    .p2align 12
L_stub13:
    s_setpc_b64 s[74:75]
    s_nop 0
L_fin13:
    s_waitcnt lgkmcnt(0)
    s_barrier
    v_mfma_f32_16x16x32_bf16 v[108:111], v[184:187], v[216:219], v[108:111]
    ds_read_b128 v[192:195], v6 offset:35840
    ds_read_b128 v[196:199], v6 offset:44032
    v_mfma_f32_16x16x32_bf16 v[108:111], v[188:191], v[220:223], v[108:111]
    ds_read_b128 v[200:203], v6 offset:36352
    ds_read_b128 v[204:207], v6 offset:44544
    v_mfma_f32_16x16x32_bf16 v[104:107], v[180:183], v[220:223], v[104:107]
    ds_read_b128 v[208:211], v6 offset:34816
    ds_read_b128 v[212:215], v6 offset:43008
    v_mfma_f32_16x16x32_bf16 v[104:107], v[176:179], v[216:219], v[104:107]
    ds_read_b128 v[128:131], v4 offset:0
    ds_read_b128 v[132:135], v5 offset:0
    v_mfma_f32_16x16x32_bf16 v[100:103], v[168:171], v[216:219], v[100:103]
    ds_read_b128 v[136:139], v4 offset:2048
    ds_read_b128 v[140:143], v5 offset:2048
    v_mfma_f32_16x16x32_bf16 v[100:103], v[172:175], v[220:223], v[100:103]
    ds_read_b128 v[144:147], v4 offset:4096
    ds_read_b128 v[148:151], v5 offset:4096
    v_mfma_f32_16x16x32_bf16 v[96:99], v[164:167], v[220:223], v[96:99]
    ds_read_b128 v[152:155], v4 offset:6144
    ds_read_b128 v[156:159], v5 offset:6144
    v_mfma_f32_16x16x32_bf16 v[96:99], v[160:163], v[216:219], v[96:99]
    s_waitcnt lgkmcnt(4)
    v_mfma_f32_16x16x32_bf16 v[112:115], v[128:131], v[192:195], v[112:115]
    ds_read_b128 v[216:219], v6 offset:35328
    v_mfma_f32_16x16x32_bf16 v[112:115], v[132:135], v[196:199], v[112:115]
    ds_read_b128 v[220:223], v6 offset:43520
    v_mfma_f32_16x16x32_bf16 v[116:119], v[140:143], v[196:199], v[116:119]
    v_mfma_f32_16x16x32_bf16 v[116:119], v[136:139], v[192:195], v[116:119]
    v_mfma_f32_16x16x32_bf16 v[124:127], v[136:139], v[200:203], v[124:127]
    v_mfma_f32_16x16x32_bf16 v[124:127], v[140:143], v[204:207], v[124:127]
    v_mfma_f32_16x16x32_bf16 v[120:123], v[132:135], v[204:207], v[120:123]
    v_mfma_f32_16x16x32_bf16 v[120:123], v[128:131], v[200:203], v[120:123]
    s_waitcnt lgkmcnt(2)
    v_mfma_f32_16x16x32_bf16 v[80:83], v[128:131], v[208:211], v[80:83]
    v_mfma_f32_16x16x32_bf16 v[80:83], v[132:135], v[212:215], v[80:83]
    v_mfma_f32_16x16x32_bf16 v[84:87], v[140:143], v[212:215], v[84:87]
    v_mfma_f32_16x16x32_bf16 v[84:87], v[136:139], v[208:211], v[84:87]
    v_mfma_f32_16x16x32_bf16 v[88:91], v[144:147], v[208:211], v[88:91]
    v_mfma_f32_16x16x32_bf16 v[88:91], v[148:151], v[212:215], v[88:91]
    v_mfma_f32_16x16x32_bf16 v[92:95], v[156:159], v[212:215], v[92:95]
    v_mfma_f32_16x16x32_bf16 v[92:95], v[152:155], v[208:211], v[92:95]
    s_waitcnt lgkmcnt(0)
    s_barrier
    v_mfma_f32_16x16x32_bf16 v[108:111], v[152:155], v[216:219], v[108:111]
    ds_read_b128 v[192:195], v6 offset:3072
    ds_read_b128 v[196:199], v6 offset:11264
    v_mfma_f32_16x16x32_bf16 v[108:111], v[156:159], v[220:223], v[108:111]
    ds_read_b128 v[200:203], v6 offset:3584
    ds_read_b128 v[204:207], v6 offset:11776
    v_mfma_f32_16x16x32_bf16 v[104:107], v[148:151], v[220:223], v[104:107]
    ds_read_b128 v[208:211], v6 offset:2048
    ds_read_b128 v[212:215], v6 offset:10240
    v_mfma_f32_16x16x32_bf16 v[104:107], v[144:147], v[216:219], v[104:107]
    ds_read_b128 v[224:227], v2 offset:0
    ds_read_b128 v[228:231], v3 offset:0
    v_mfma_f32_16x16x32_bf16 v[100:103], v[136:139], v[216:219], v[100:103]
    ds_read_b128 v[232:235], v2 offset:2048
    ds_read_b128 v[236:239], v3 offset:2048
    v_mfma_f32_16x16x32_bf16 v[100:103], v[140:143], v[220:223], v[100:103]
    ds_read_b128 v[240:243], v2 offset:4096
    ds_read_b128 v[244:247], v3 offset:4096
    v_mfma_f32_16x16x32_bf16 v[96:99], v[132:135], v[220:223], v[96:99]
    ds_read_b128 v[248:251], v2 offset:6144
    ds_read_b128 v[252:255], v3 offset:6144
    v_mfma_f32_16x16x32_bf16 v[96:99], v[128:131], v[216:219], v[96:99]
    s_waitcnt lgkmcnt(4)
    v_mfma_f32_16x16x32_bf16 v[112:115], v[224:227], v[192:195], v[112:115]
    ds_read_b128 v[216:219], v6 offset:2560
    v_mfma_f32_16x16x32_bf16 v[112:115], v[228:231], v[196:199], v[112:115]
    ds_read_b128 v[220:223], v6 offset:10752
    v_mfma_f32_16x16x32_bf16 v[116:119], v[236:239], v[196:199], v[116:119]
    v_mfma_f32_16x16x32_bf16 v[116:119], v[232:235], v[192:195], v[116:119]
    v_mfma_f32_16x16x32_bf16 v[124:127], v[232:235], v[200:203], v[124:127]
    ds_read_b128 v[192:195], v6 offset:16384
    v_mfma_f32_16x16x32_bf16 v[124:127], v[236:239], v[204:207], v[124:127]
    ds_read_b128 v[196:199], v6 offset:24576
    v_mfma_f32_16x16x32_bf16 v[120:123], v[228:231], v[204:207], v[120:123]
    v_mfma_f32_16x16x32_bf16 v[120:123], v[224:227], v[200:203], v[120:123]
    s_waitcnt lgkmcnt(4)
    v_mfma_f32_16x16x32_bf16 v[80:83], v[224:227], v[208:211], v[80:83]
    ds_read_b128 v[200:203], v6 offset:16896
    v_mfma_f32_16x16x32_bf16 v[80:83], v[228:231], v[212:215], v[80:83]
    ds_read_b128 v[204:207], v6 offset:25088
    v_mfma_f32_16x16x32_bf16 v[84:87], v[236:239], v[212:215], v[84:87]
    v_mfma_f32_16x16x32_bf16 v[84:87], v[232:235], v[208:211], v[84:87]
    v_mfma_f32_16x16x32_bf16 v[88:91], v[240:243], v[208:211], v[88:91]
    v_mfma_f32_16x16x32_bf16 v[88:91], v[244:247], v[212:215], v[88:91]
    v_mfma_f32_16x16x32_bf16 v[92:95], v[252:255], v[212:215], v[92:95]
    s_add_u32 s45, s48, 0
    v_cvt_pk_bf16_f32 v112, v112, v120
    buffer_store_dword v112, v8, s[32:35], s45 offen sc1
    v_mfma_f32_16x16x32_bf16 v[92:95], v[248:251], v[208:211], v[92:95]
    s_add_u32 s45, s48, 7168
    v_cvt_pk_bf16_f32 v113, v113, v121
    buffer_store_dword v113, v8, s[32:35], s45 offen sc1
    s_waitcnt lgkmcnt(4)
    v_mfma_f32_16x16x32_bf16 v[108:111], v[248:251], v[216:219], v[108:111]
    s_add_u32 s45, s48, 14336
    v_cvt_pk_bf16_f32 v114, v114, v122
    buffer_store_dword v114, v8, s[32:35], s45 offen sc1
    ds_read_b128 v[208:211], v6 offset:32768
    v_mfma_f32_16x16x32_bf16 v[108:111], v[252:255], v[220:223], v[108:111]
    ds_read_b128 v[212:215], v6 offset:40960
    v_mfma_f32_16x16x32_bf16 v[104:107], v[244:247], v[220:223], v[104:107]
    s_add_u32 s45, s48, 21504
    v_cvt_pk_bf16_f32 v115, v115, v123
    buffer_store_dword v115, v8, s[32:35], s45 offen sc1
    v_mfma_f32_16x16x32_bf16 v[104:107], v[240:243], v[216:219], v[104:107]
    v_mfma_f32_16x16x32_bf16 v[100:103], v[232:235], v[216:219], v[100:103]
    s_add_u32 s45, s48, 114688
    v_cvt_pk_bf16_f32 v116, v116, v124
    buffer_store_dword v116, v8, s[32:35], s45 offen sc1
    v_mfma_f32_16x16x32_bf16 v[100:103], v[236:239], v[220:223], v[100:103]
    v_mfma_f32_16x16x32_bf16 v[96:99], v[228:231], v[220:223], v[96:99]
    s_add_u32 s45, s48, 121856
    v_cvt_pk_bf16_f32 v117, v117, v125
    buffer_store_dword v117, v8, s[32:35], s45 offen sc1
    v_mfma_f32_16x16x32_bf16 v[96:99], v[224:227], v[216:219], v[96:99]
    s_waitcnt lgkmcnt(4)
    v_mfma_f32_16x16x32_bf16 v[16:19], v[160:163], v[192:195], v[16:19]
    s_add_u32 s45, s48, 129024
    v_cvt_pk_bf16_f32 v118, v118, v126
    buffer_store_dword v118, v8, s[32:35], s45 offen sc1
    ds_read_b128 v[216:219], v6 offset:33280
    v_mfma_f32_16x16x32_bf16 v[16:19], v[164:167], v[196:199], v[16:19]
    ds_read_b128 v[220:223], v6 offset:41472
    v_mfma_f32_16x16x32_bf16 v[20:23], v[172:175], v[196:199], v[20:23]
    s_add_u32 s45, s48, 136192
    v_cvt_pk_bf16_f32 v119, v119, v127
    buffer_store_dword v119, v8, s[32:35], s45 offen sc1
    v_mfma_f32_16x16x32_bf16 v[20:23], v[168:171], v[192:195], v[20:23]
    v_mfma_f32_16x16x32_bf16 v[24:27], v[176:179], v[192:195], v[24:27]
    v_mfma_f32_16x16x32_bf16 v[24:27], v[180:183], v[196:199], v[24:27]
    v_mfma_f32_16x16x32_bf16 v[28:31], v[188:191], v[196:199], v[28:31]
    s_add_u32 s45, s48, 0
    v_cvt_pk_bf16_f32 v80, v80, v96
    buffer_store_dword v80, v7, s[32:35], s45 offen offset:128 sc1
    v_mfma_f32_16x16x32_bf16 v[28:31], v[184:187], v[192:195], v[28:31]
    s_add_u32 s45, s48, 7168
    v_cvt_pk_bf16_f32 v81, v81, v97
    buffer_store_dword v81, v7, s[32:35], s45 offen offset:128 sc1
    s_waitcnt lgkmcnt(4)
    v_mfma_f32_16x16x32_bf16 v[44:47], v[184:187], v[200:203], v[44:47]
    s_add_u32 s45, s48, 14336
    v_cvt_pk_bf16_f32 v82, v82, v98
    buffer_store_dword v82, v7, s[32:35], s45 offen offset:128 sc1
    ds_read_b128 v[192:195], v6 offset:0
    v_mfma_f32_16x16x32_bf16 v[44:47], v[188:191], v[204:207], v[44:47]
    ds_read_b128 v[196:199], v6 offset:8192
    v_mfma_f32_16x16x32_bf16 v[40:43], v[180:183], v[204:207], v[40:43]
    s_add_u32 s45, s48, 21504
    v_cvt_pk_bf16_f32 v83, v83, v99
    buffer_store_dword v83, v7, s[32:35], s45 offen offset:128 sc1
    v_mfma_f32_16x16x32_bf16 v[40:43], v[176:179], v[200:203], v[40:43]
    v_mfma_f32_16x16x32_bf16 v[36:39], v[168:171], v[200:203], v[36:39]
    s_add_u32 s45, s48, 114688
    v_cvt_pk_bf16_f32 v84, v84, v100
    buffer_store_dword v84, v7, s[32:35], s45 offen offset:128 sc1
    v_mfma_f32_16x16x32_bf16 v[36:39], v[172:175], v[204:207], v[36:39]
    v_mfma_f32_16x16x32_bf16 v[32:35], v[164:167], v[204:207], v[32:35]
    s_add_u32 s45, s48, 121856
    v_cvt_pk_bf16_f32 v85, v85, v101
    buffer_store_dword v85, v7, s[32:35], s45 offen offset:128 sc1
    v_mfma_f32_16x16x32_bf16 v[32:35], v[160:163], v[200:203], v[32:35]
    s_waitcnt lgkmcnt(4)
    v_mfma_f32_16x16x32_bf16 v[16:19], v[128:131], v[208:211], v[16:19]
    s_add_u32 s45, s48, 129024
    v_cvt_pk_bf16_f32 v86, v86, v102
    buffer_store_dword v86, v7, s[32:35], s45 offen offset:128 sc1
    ds_read_b128 v[200:203], v6 offset:512
    v_mfma_f32_16x16x32_bf16 v[16:19], v[132:135], v[212:215], v[16:19]
    ds_read_b128 v[204:207], v6 offset:8704
    v_mfma_f32_16x16x32_bf16 v[20:23], v[140:143], v[212:215], v[20:23]
    s_add_u32 s45, s48, 136192
    v_cvt_pk_bf16_f32 v87, v87, v103
    buffer_store_dword v87, v7, s[32:35], s45 offen offset:128 sc1
    v_mfma_f32_16x16x32_bf16 v[20:23], v[136:139], v[208:211], v[20:23]
    v_mfma_f32_16x16x32_bf16 v[24:27], v[144:147], v[208:211], v[24:27]
    s_add_u32 s45, s49, 0
    v_cvt_pk_bf16_f32 v88, v88, v104
    buffer_store_dword v88, v7, s[32:35], s45 offen offset:128 sc1
    v_mfma_f32_16x16x32_bf16 v[24:27], v[148:151], v[212:215], v[24:27]
    v_mfma_f32_16x16x32_bf16 v[28:31], v[156:159], v[212:215], v[28:31]
    s_add_u32 s45, s49, 7168
    v_cvt_pk_bf16_f32 v89, v89, v105
    buffer_store_dword v89, v7, s[32:35], s45 offen offset:128 sc1
    v_mfma_f32_16x16x32_bf16 v[28:31], v[152:155], v[208:211], v[28:31]
    s_waitcnt lgkmcnt(4)
    v_mfma_f32_16x16x32_bf16 v[44:47], v[152:155], v[216:219], v[44:47]
    s_add_u32 s45, s49, 14336
    v_cvt_pk_bf16_f32 v90, v90, v106
    buffer_store_dword v90, v7, s[32:35], s45 offen offset:128 sc1
    ds_read_b128 v[208:211], v6 offset:17408
    v_mfma_f32_16x16x32_bf16 v[44:47], v[156:159], v[220:223], v[44:47]
    ds_read_b128 v[212:215], v6 offset:25600
    v_mfma_f32_16x16x32_bf16 v[40:43], v[148:151], v[220:223], v[40:43]
    s_add_u32 s45, s49, 21504
    v_cvt_pk_bf16_f32 v91, v91, v107
    buffer_store_dword v91, v7, s[32:35], s45 offen offset:128 sc1
    v_mfma_f32_16x16x32_bf16 v[40:43], v[144:147], v[216:219], v[40:43]
    v_mfma_f32_16x16x32_bf16 v[36:39], v[136:139], v[216:219], v[36:39]
    s_add_u32 s45, s49, 114688
    v_cvt_pk_bf16_f32 v92, v92, v108
    buffer_store_dword v92, v7, s[32:35], s45 offen offset:128 sc1
    v_mfma_f32_16x16x32_bf16 v[36:39], v[140:143], v[220:223], v[36:39]
    v_mfma_f32_16x16x32_bf16 v[32:35], v[132:135], v[220:223], v[32:35]
    s_add_u32 s45, s49, 121856
    v_cvt_pk_bf16_f32 v93, v93, v109
    buffer_store_dword v93, v7, s[32:35], s45 offen offset:128 sc1
    v_mfma_f32_16x16x32_bf16 v[32:35], v[128:131], v[216:219], v[32:35]
    s_waitcnt lgkmcnt(4)
    v_mfma_f32_16x16x32_bf16 v[16:19], v[224:227], v[192:195], v[16:19]
    s_add_u32 s45, s49, 129024
    v_cvt_pk_bf16_f32 v94, v94, v110
    buffer_store_dword v94, v7, s[32:35], s45 offen offset:128 sc1
    ds_read_b128 v[216:219], v6 offset:17920
    v_mfma_f32_16x16x32_bf16 v[16:19], v[228:231], v[196:199], v[16:19]
    ds_read_b128 v[220:223], v6 offset:26112
    v_mfma_f32_16x16x32_bf16 v[20:23], v[236:239], v[196:199], v[20:23]
    s_add_u32 s45, s49, 136192
    v_cvt_pk_bf16_f32 v95, v95, v111
    buffer_store_dword v95, v7, s[32:35], s45 offen offset:128 sc1
    v_mfma_f32_16x16x32_bf16 v[20:23], v[232:235], v[192:195], v[20:23]
    v_mfma_f32_16x16x32_bf16 v[24:27], v[240:243], v[192:195], v[24:27]
    v_mfma_f32_16x16x32_bf16 v[24:27], v[244:247], v[196:199], v[24:27]
    v_mfma_f32_16x16x32_bf16 v[28:31], v[252:255], v[196:199], v[28:31]
    v_mfma_f32_16x16x32_bf16 v[28:31], v[248:251], v[192:195], v[28:31]
    s_waitcnt lgkmcnt(4)
    v_mfma_f32_16x16x32_bf16 v[44:47], v[248:251], v[200:203], v[44:47]
    ds_read_b128 v[192:195], v6 offset:33792
    v_mfma_f32_16x16x32_bf16 v[44:47], v[252:255], v[204:207], v[44:47]
    ds_read_b128 v[196:199], v6 offset:41984
    v_mfma_f32_16x16x32_bf16 v[40:43], v[244:247], v[204:207], v[40:43]
    v_mfma_f32_16x16x32_bf16 v[40:43], v[240:243], v[200:203], v[40:43]
    v_mfma_f32_16x16x32_bf16 v[36:39], v[232:235], v[200:203], v[36:39]
    v_mfma_f32_16x16x32_bf16 v[36:39], v[236:239], v[204:207], v[36:39]
    v_mfma_f32_16x16x32_bf16 v[32:35], v[228:231], v[204:207], v[32:35]
    v_mfma_f32_16x16x32_bf16 v[32:35], v[224:227], v[200:203], v[32:35]
    s_waitcnt lgkmcnt(4)
    v_mfma_f32_16x16x32_bf16 v[48:51], v[160:163], v[208:211], v[48:51]
    ds_read_b128 v[200:203], v6 offset:34304
    v_mfma_f32_16x16x32_bf16 v[48:51], v[164:167], v[212:215], v[48:51]
    ds_read_b128 v[204:207], v6 offset:42496
    v_mfma_f32_16x16x32_bf16 v[52:55], v[172:175], v[212:215], v[52:55]
    v_mfma_f32_16x16x32_bf16 v[52:55], v[168:171], v[208:211], v[52:55]
    v_mfma_f32_16x16x32_bf16 v[56:59], v[176:179], v[208:211], v[56:59]
    v_mfma_f32_16x16x32_bf16 v[56:59], v[180:183], v[212:215], v[56:59]
    v_mfma_f32_16x16x32_bf16 v[60:63], v[188:191], v[212:215], v[60:63]
    s_add_u32 s45, s48, 0
    v_cvt_pk_bf16_f32 v16, v16, v32
    buffer_store_dword v16, v7, s[32:35], s45 offen offset:0 sc1
    v_mfma_f32_16x16x32_bf16 v[60:63], v[184:187], v[208:211], v[60:63]
    s_add_u32 s45, s48, 7168
    v_cvt_pk_bf16_f32 v17, v17, v33
    buffer_store_dword v17, v7, s[32:35], s45 offen offset:0 sc1
    s_waitcnt lgkmcnt(4)
    v_mfma_f32_16x16x32_bf16 v[76:79], v[184:187], v[216:219], v[76:79]
    s_add_u32 s45, s48, 14336
    v_cvt_pk_bf16_f32 v18, v18, v34
    buffer_store_dword v18, v7, s[32:35], s45 offen offset:0 sc1
    ds_read_b128 v[208:211], v6 offset:1024
    v_mfma_f32_16x16x32_bf16 v[76:79], v[188:191], v[220:223], v[76:79]
    ds_read_b128 v[212:215], v6 offset:9216
    v_mfma_f32_16x16x32_bf16 v[72:75], v[180:183], v[220:223], v[72:75]
    s_add_u32 s45, s48, 21504
    v_cvt_pk_bf16_f32 v19, v19, v35
    buffer_store_dword v19, v7, s[32:35], s45 offen offset:0 sc1
    v_mfma_f32_16x16x32_bf16 v[72:75], v[176:179], v[216:219], v[72:75]
    v_mfma_f32_16x16x32_bf16 v[68:71], v[168:171], v[216:219], v[68:71]
    s_add_u32 s45, s48, 114688
    v_cvt_pk_bf16_f32 v20, v20, v36
    buffer_store_dword v20, v7, s[32:35], s45 offen offset:0 sc1
    v_mfma_f32_16x16x32_bf16 v[68:71], v[172:175], v[220:223], v[68:71]
    v_mfma_f32_16x16x32_bf16 v[64:67], v[164:167], v[220:223], v[64:67]
    s_add_u32 s45, s48, 121856
    v_cvt_pk_bf16_f32 v21, v21, v37
    buffer_store_dword v21, v7, s[32:35], s45 offen offset:0 sc1
    v_mfma_f32_16x16x32_bf16 v[64:67], v[160:163], v[216:219], v[64:67]
    s_waitcnt lgkmcnt(4)
    v_mfma_f32_16x16x32_bf16 v[48:51], v[128:131], v[192:195], v[48:51]
    s_add_u32 s45, s48, 129024
    v_cvt_pk_bf16_f32 v22, v22, v38
    buffer_store_dword v22, v7, s[32:35], s45 offen offset:0 sc1
    ds_read_b128 v[216:219], v6 offset:1536
    v_mfma_f32_16x16x32_bf16 v[48:51], v[132:135], v[196:199], v[48:51]
    ds_read_b128 v[220:223], v6 offset:9728
    v_mfma_f32_16x16x32_bf16 v[52:55], v[140:143], v[196:199], v[52:55]
    s_add_u32 s45, s48, 136192
    v_cvt_pk_bf16_f32 v23, v23, v39
    buffer_store_dword v23, v7, s[32:35], s45 offen offset:0 sc1
    v_mfma_f32_16x16x32_bf16 v[52:55], v[136:139], v[192:195], v[52:55]
    v_mfma_f32_16x16x32_bf16 v[56:59], v[144:147], v[192:195], v[56:59]
    s_add_u32 s45, s49, 0
    v_cvt_pk_bf16_f32 v24, v24, v40
    buffer_store_dword v24, v7, s[32:35], s45 offen offset:0 sc1
    v_mfma_f32_16x16x32_bf16 v[56:59], v[148:151], v[196:199], v[56:59]
    v_mfma_f32_16x16x32_bf16 v[60:63], v[156:159], v[196:199], v[60:63]
    s_add_u32 s45, s49, 7168
    v_cvt_pk_bf16_f32 v25, v25, v41
    buffer_store_dword v25, v7, s[32:35], s45 offen offset:0 sc1
    v_mfma_f32_16x16x32_bf16 v[60:63], v[152:155], v[192:195], v[60:63]
    s_waitcnt lgkmcnt(4)
    v_mfma_f32_16x16x32_bf16 v[76:79], v[152:155], v[200:203], v[76:79]
    s_add_u32 s45, s49, 14336
    v_cvt_pk_bf16_f32 v26, v26, v42
    buffer_store_dword v26, v7, s[32:35], s45 offen offset:0 sc1
    v_mfma_f32_16x16x32_bf16 v[76:79], v[156:159], v[204:207], v[76:79]
    v_mfma_f32_16x16x32_bf16 v[72:75], v[148:151], v[204:207], v[72:75]
    s_add_u32 s45, s49, 21504
    v_cvt_pk_bf16_f32 v27, v27, v43
    buffer_store_dword v27, v7, s[32:35], s45 offen offset:0 sc1
    v_mfma_f32_16x16x32_bf16 v[72:75], v[144:147], v[200:203], v[72:75]
    v_mfma_f32_16x16x32_bf16 v[68:71], v[136:139], v[200:203], v[68:71]
    s_add_u32 s45, s49, 114688
    v_cvt_pk_bf16_f32 v28, v28, v44
    buffer_store_dword v28, v7, s[32:35], s45 offen offset:0 sc1
    v_mfma_f32_16x16x32_bf16 v[68:71], v[140:143], v[204:207], v[68:71]
    v_mfma_f32_16x16x32_bf16 v[64:67], v[132:135], v[204:207], v[64:67]
    s_add_u32 s45, s49, 121856
    v_cvt_pk_bf16_f32 v29, v29, v45
    buffer_store_dword v29, v7, s[32:35], s45 offen offset:0 sc1
    v_mfma_f32_16x16x32_bf16 v[64:67], v[128:131], v[200:203], v[64:67]
    s_waitcnt lgkmcnt(2)
    v_mfma_f32_16x16x32_bf16 v[48:51], v[224:227], v[208:211], v[48:51]
    s_add_u32 s45, s49, 129024
    v_cvt_pk_bf16_f32 v30, v30, v46
    buffer_store_dword v30, v7, s[32:35], s45 offen offset:0 sc1
    v_mfma_f32_16x16x32_bf16 v[48:51], v[228:231], v[212:215], v[48:51]
    v_mfma_f32_16x16x32_bf16 v[52:55], v[236:239], v[212:215], v[52:55]
    s_add_u32 s45, s49, 136192
    v_cvt_pk_bf16_f32 v31, v31, v47
    buffer_store_dword v31, v7, s[32:35], s45 offen offset:0 sc1
    v_mfma_f32_16x16x32_bf16 v[52:55], v[232:235], v[208:211], v[52:55]
    v_mfma_f32_16x16x32_bf16 v[56:59], v[240:243], v[208:211], v[56:59]
    v_mfma_f32_16x16x32_bf16 v[56:59], v[244:247], v[212:215], v[56:59]
    v_mfma_f32_16x16x32_bf16 v[60:63], v[252:255], v[212:215], v[60:63]
    v_mfma_f32_16x16x32_bf16 v[60:63], v[248:251], v[208:211], v[60:63]
    s_waitcnt lgkmcnt(0)
    v_mfma_f32_16x16x32_bf16 v[76:79], v[248:251], v[216:219], v[76:79]
    v_mfma_f32_16x16x32_bf16 v[76:79], v[252:255], v[220:223], v[76:79]
    v_mfma_f32_16x16x32_bf16 v[72:75], v[244:247], v[220:223], v[72:75]
    v_mfma_f32_16x16x32_bf16 v[72:75], v[240:243], v[216:219], v[72:75]
    v_mfma_f32_16x16x32_bf16 v[68:71], v[232:235], v[216:219], v[68:71]
    v_mfma_f32_16x16x32_bf16 v[68:71], v[236:239], v[220:223], v[68:71]
    v_mfma_f32_16x16x32_bf16 v[64:67], v[228:231], v[220:223], v[64:67]
    v_mfma_f32_16x16x32_bf16 v[64:67], v[224:227], v[216:219], v[64:67]
    s_nop 7
    s_add_u32 s45, s48, 0
    v_cvt_pk_bf16_f32 v48, v48, v64
    buffer_store_dword v48, v7, s[32:35], s45 offen offset:64 sc1
    s_add_u32 s45, s48, 7168
    v_cvt_pk_bf16_f32 v49, v49, v65
    buffer_store_dword v49, v7, s[32:35], s45 offen offset:64 sc1
    s_add_u32 s45, s48, 14336
    v_cvt_pk_bf16_f32 v50, v50, v66
    buffer_store_dword v50, v7, s[32:35], s45 offen offset:64 sc1
    s_add_u32 s45, s48, 21504
    v_cvt_pk_bf16_f32 v51, v51, v67
    buffer_store_dword v51, v7, s[32:35], s45 offen offset:64 sc1
    s_add_u32 s45, s48, 114688
    v_cvt_pk_bf16_f32 v52, v52, v68
    buffer_store_dword v52, v7, s[32:35], s45 offen offset:64 sc1
    s_add_u32 s45, s48, 121856
    v_cvt_pk_bf16_f32 v53, v53, v69
    buffer_store_dword v53, v7, s[32:35], s45 offen offset:64 sc1
    s_add_u32 s45, s48, 129024
    v_cvt_pk_bf16_f32 v54, v54, v70
    buffer_store_dword v54, v7, s[32:35], s45 offen offset:64 sc1
    s_add_u32 s45, s48, 136192
    v_cvt_pk_bf16_f32 v55, v55, v71
    buffer_store_dword v55, v7, s[32:35], s45 offen offset:64 sc1
    s_add_u32 s45, s49, 0
    v_cvt_pk_bf16_f32 v56, v56, v72
    buffer_store_dword v56, v7, s[32:35], s45 offen offset:64 sc1
    s_add_u32 s45, s49, 7168
    v_cvt_pk_bf16_f32 v57, v57, v73
    buffer_store_dword v57, v7, s[32:35], s45 offen offset:64 sc1
    s_add_u32 s45, s49, 14336
    v_cvt_pk_bf16_f32 v58, v58, v74
    buffer_store_dword v58, v7, s[32:35], s45 offen offset:64 sc1
    s_add_u32 s45, s49, 21504
    v_cvt_pk_bf16_f32 v59, v59, v75
    buffer_store_dword v59, v7, s[32:35], s45 offen offset:64 sc1
    s_add_u32 s45, s49, 114688
    v_cvt_pk_bf16_f32 v60, v60, v76
    buffer_store_dword v60, v7, s[32:35], s45 offen offset:64 sc1
    s_add_u32 s45, s49, 121856
    v_cvt_pk_bf16_f32 v61, v61, v77
    buffer_store_dword v61, v7, s[32:35], s45 offen offset:64 sc1
    s_add_u32 s45, s49, 129024
    v_cvt_pk_bf16_f32 v62, v62, v78
    buffer_store_dword v62, v7, s[32:35], s45 offen offset:64 sc1
    s_add_u32 s45, s49, 136192
    v_cvt_pk_bf16_f32 v63, v63, v79
    buffer_store_dword v63, v7, s[32:35], s45 offen offset:64 sc1
L_end:
    s_endpgm
L_last:
.section .rodata,"a"
.p2align 6
.amdhsa_kernel standalone__normalfloat_lut_codebook_lookup__prompt_kernel
  .amdhsa_next_free_vgpr 256
  .amdhsa_next_free_sgpr 96
  .amdhsa_accum_offset 256
  .amdhsa_group_segment_fixed_size 0
  .amdhsa_kernarg_size 56
  .amdhsa_user_sgpr_count 2
  .amdhsa_user_sgpr_kernarg_segment_ptr 1
  .amdhsa_system_sgpr_workgroup_id_x 1
  .amdhsa_float_denorm_mode_32 3
.end_amdhsa_kernel
.text
```
